```python
import torch

def _softmax(x, axis=-1):
    return torch.softmax(x, dim=axis)
def _gelu(x):
    return torch.nn.functional.gelu(x, approximate="tanh")
def _silu(x):
    return torch.nn.functional.silu(x)
def _sigmoid(x):
    return torch.sigmoid(x)
def _layernorm(x, axis=-1, eps=1e-5):
    m = x.mean(dim=axis, keepdim=True)
    v = x.var(dim=axis, keepdim=True, unbiased=False)
    return (x - m) / torch.sqrt(v + eps)
def _scatter_add(tgt, idx, src, axis=0):
    return tgt.clone().index_add_(axis, idx, src)
def _segment_sum(src, seg, n):
    out = torch.zeros((n,) + src.shape[1:], dtype=src.dtype)
    return out.index_add_(0, seg, src)
def _pad(x, pw):
    flat = tuple(v for pair in reversed(pw) for v in pair)
    return torch.nn.functional.pad(x, flat)

kernel_name = 'parallel_sum__compressed_kv_cla__glu_gated_reglu__prompt'

def setup_inputs():

    _w = (lambda a: (lambda t: t.to(torch.bfloat16) if t.is_floating_point() else t)(torch.as_tensor(a)))
    def _A_setup():
        B, H, Sq, Sk, D, M = 1, 32, 2048, 2048, 128, 640
        Dc = 4 * D
        return {
            "x": _w((lambda *s: torch.randn(*s, dtype=torch.bfloat16) * 0.05)(B, Sq, M)),
            "c_kv": _w((lambda *s: torch.randn(*s, dtype=torch.bfloat16) * 0.4)(B, Sk, Dc)),
            "w_q": _w((lambda *s: torch.randn(*s, dtype=torch.bfloat16) * 1.6)(M, H, D) * (M ** -0.5)),
            "w_uk": _w((lambda *s: torch.randn(*s, dtype=torch.bfloat16) * 1.6)(Dc, H, D) * (Dc ** -0.5)),
            "w_uv": _w((lambda *s: torch.randn(*s, dtype=torch.bfloat16) * 0.4)(Dc, H, D) * (Dc ** -0.5)),
            "w_o": _w((lambda *s: torch.randn(*s, dtype=torch.bfloat16) * 0.4)(H, D, M) * ((H * D) ** -0.5)),
        }
    _A_in = _A_setup()

    def _B_setup():
        B, S, D, F = 1, 2048, 640, 1728
        return {
            "x": _w((lambda *s: torch.randn(*s, dtype=torch.bfloat16) * 0.05)(B, S, D)),
            "W_gate": _w((lambda *s: torch.randn(*s, dtype=torch.bfloat16) * 0.2)(D, F) * (2.0 / D) ** 0.5),
            "W_up": _w((lambda *s: torch.randn(*s, dtype=torch.bfloat16) * 0.2)(D, F) * (2.0 / D) ** 0.5),
            "W_down": _w((lambda *s: torch.randn(*s, dtype=torch.bfloat16) * 0.2)(F, D) * (1.0 / F) ** 0.5),
        }
    _B_in = _B_setup()

    return {
        "A_x": _A_in["x"],
        "A_c_kv": _A_in["c_kv"],
        "A_w_q": _A_in["w_q"],
        "A_w_uk": _A_in["w_uk"],
        "A_w_uv": _A_in["w_uv"],
        "A_w_o": _A_in["w_o"],
        "B_x": _B_in["x"],
        "B_W_gate": _B_in["W_gate"],
        "B_W_up": _B_in["W_up"],
        "B_W_down": _B_in["W_down"],
    }

def reference(A_x, A_c_kv, A_w_q, A_w_uk, A_w_uv, A_w_o, B_x, B_W_gate, B_W_up, B_W_down):
    def _A_ref(x, c_kv, w_q, w_uk, w_uv, w_o):
        B, Sq, M = x.shape[0], x.shape[1], x.shape[2]
        Sk = c_kv.shape[1]
        H, D = w_q.shape[1], w_q.shape[2]
        q = torch.einsum("bqm,mhd->bhqd", x, w_q)
        k = torch.einsum("bkc,chd->bhkd", c_kv, w_uk)
        v = torch.einsum("bkc,chd->bhkd", c_kv, w_uv)
        scores = torch.einsum("bhqd,bhkd->bhqk", q, k) * (D ** -0.5)
        off = Sk - Sq
        qi = torch.arange(Sq)[:, None]
        kj = torch.arange(Sk)[None, :]
        cmask = kj <= (qi + off)
        scores = torch.where(cmask[None, None], scores, -1e9)
        p = _softmax(scores, axis=-1)
        ctx = torch.einsum("bhqk,bhkd->bhqd", p, v)
        return torch.einsum("bhqd,hdm->bqm", ctx, w_o)

    def _B_ref(x, W_gate, W_up, W_down):
        gate = torch.einsum("bsd,df->bsf", x, W_gate)
        up = torch.einsum("bsd,df->bsf", x, W_up)
        gate = gate * (lambda x, dt: x.to(dt))(gate > 0, gate.dtype)
        h = gate * up
        return torch.einsum("bsf,fd->bsd", h, W_down)

    x = A_x
    xn = _layernorm(x, axis=-1)
    return x + _A_ref(xn, A_c_kv, A_w_q, A_w_uk, A_w_uv, A_w_o) + _B_ref(xn, B_W_gate, B_W_up, B_W_down)
```

```asm
; @launch kernel=proj_kernel grid=(256,1,1) block=(512,1,1) lds=163840
.amdgcn_target "amdgcn-amd-amdhsa--gfx950"
.text
.globl proj_kernel
.p2align 8
.type proj_kernel,@function
proj_kernel:
    s_cmp_ge_u32 s2, 256
    s_cbranch_scc1 proj_kernel_done
    s_load_dwordx4 s[40:43], s[0:1], 0
    s_load_dwordx4 s[44:47], s[0:1], 16
    s_load_dwordx2 s[48:49], s[0:1], 32
    s_load_dwordx4 s[52:55], s[0:1], 56
    s_load_dwordx2 s[50:51], s[0:1], 88
    s_load_dwordx2 s[56:57], s[0:1], 96
    s_and_b32 s3, s2, 7
    s_lshr_b32 s36, s2, 3
    s_and_b32 s37, s36, 7
    s_lshr_b32 s36, s36, 3
    s_lshl_b32 s36, s36, 3
    s_add_u32 s36, s36, s3
    s_xor_b32 s61, s36, 16
    v_and_b32 v1, 63, v0
    v_lshrrev_b32 v2, 6, v0
    s_nop 0
    v_readfirstlane_b32 s21, v2
    s_lshl_b32 s17, s2, 3
    s_add_u32 s17, s17, s21
    s_mul_i32 s17, s17, 1280
    s_waitcnt lgkmcnt(0)
    s_mov_b32 s8, s40
    s_and_b32 s9, s41, 0xffff
    s_mov_b32 s10, 2621440
    s_mov_b32 s11, 0x00020000
    v_lshlrev_b32 v228, 2, v1
    buffer_load_dword v210, v228, s[8:11], s17 offen offset:0
    buffer_load_dword v211, v228, s[8:11], s17 offen offset:256
    buffer_load_dword v212, v228, s[8:11], s17 offen offset:512
    buffer_load_dword v213, v228, s[8:11], s17 offen offset:768
    buffer_load_dword v214, v228, s[8:11], s17 offen offset:1024
    s_mov_b32 s12, s56
    s_and_b32 s13, s57, 0xffff
    s_mov_b32 s14, 268435456
    s_mov_b32 s15, 0x00020000
    s_lshr_b32 s38, s21, 2
    s_mov_b32 s4, s42
    s_and_b32 s5, s43, 0xffff
    s_mov_b32 s6, 2097152
    s_mov_b32 s7, 0x00020000
    s_mov_b32 s24, 1024
    s_mov_b32 s25, 8192
    s_mov_b32 s16, 8
    s_lshl_b32 s18, s37, 18
    s_cmp_lt_u32 s36, 16
    s_cselect_b32 s30, 1, 2
    s_cselect_b32 s42, s46, s48
    s_cselect_b32 s43, s47, s49
    s_and_b32 s36, s36, 15
    s_and_b32 s28, s21, 1
    s_lshl_b32 s28, s28, 7
    s_mov_b32 s8, s42
    s_and_b32 s9, s43, 0xffff
    s_mov_b32 s10, 4194304
    s_mov_b32 s11, 0x00020000
    s_lshl_b32 s19, s36, 1
    s_add_u32 s19, s19, s38
    s_lshl_b32 s19, s19, 8
    s_lshl_b32 s32, s38, 13
    s_mov_b32 s34, s32
    s_bfe_u32 s39, s21, 0x10001
    s_lshl_b32 s33, s39, 3
    s_add_u32 s35, s33, 4
    s_lshl_b32 s29, s21, 5
    v_lshrrev_b32 v204, 3, v1
    v_add_u32 v204, s29, v204
    v_lshrrev_b32 v205, 4, v1
    v_and_b32 v206, 7, v1
    v_add_u32 v207, 0, v204
    v_mul_lo_u32 v207, v207, s24
    v_add_u32 v208, 0, v205
    v_xor_b32 v208, v208, v206
    v_lshl_add_u32 v2, v208, 4, v207
    v_add_u32 v207, 8, v204
    v_mul_lo_u32 v207, v207, s24
    v_add_u32 v208, 4, v205
    v_xor_b32 v208, v208, v206
    v_lshl_add_u32 v3, v208, 4, v207
    v_add_u32 v207, 16, v204
    v_mul_lo_u32 v207, v207, s24
    v_add_u32 v208, 0, v205
    v_xor_b32 v208, v208, v206
    v_lshl_add_u32 v4, v208, 4, v207
    v_add_u32 v207, 24, v204
    v_mul_lo_u32 v207, v207, s24
    v_add_u32 v208, 4, v205
    v_xor_b32 v208, v208, v206
    v_lshl_add_u32 v5, v208, 4, v207
    s_and_b32 s29, s21, 3
    s_lshl_b32 s29, s29, 3
    v_lshrrev_b32 v205, 4, v1
    v_add_u32 v204, s29, v205
    v_lshlrev_b32 v205, 2, v205
    v_and_b32 v206, 15, v1
    v_xor_b32 v206, v206, v205
    v_lshlrev_b32 v206, 4, v206
    v_add_u32 v207, 0, v204
    v_mul_lo_u32 v207, v207, s25
    v_add_u32 v6, v207, v206
    v_add_u32 v207, 4, v204
    v_mul_lo_u32 v207, v207, s25
    v_add_u32 v7, v207, v206
    s_lshl_b32 s20, s25, 5
    s_lshl_b32 s22, s21, 12
    s_lshl_b32 s23, s21, 11
    s_add_u32 s23, s23, 0x18000
    s_mov_b32 s27, 0
    s_mov_b32 s70, 0xffff0000
    s_mov_b32 s71, 0x8000
    s_add_u32 m0, s22, 0
    s_nop 0
    buffer_load_dwordx4 v2, s[4:7], s18 offen sc1 lds
    s_add_u32 m0, s22, 1024
    s_nop 0
    buffer_load_dwordx4 v3, s[4:7], s18 offen sc1 lds
    s_add_u32 m0, s22, 2048
    s_nop 0
    buffer_load_dwordx4 v4, s[4:7], s18 offen sc1 lds
    s_add_u32 m0, s22, 3072
    s_nop 0
    buffer_load_dwordx4 v5, s[4:7], s18 offen sc1 lds
    s_add_u32 s18, s18, 128
    s_add_u32 s22, s22, 0x8000
    s_cmp_ge_u32 s22, 0x18000
    s_cbranch_scc0 1f
    s_sub_u32 s22, s22, 0x18000
    1:
    s_add_u32 m0, s23, 0
    s_nop 0
    buffer_load_dwordx4 v6, s[8:11], s19 offen lds
    s_add_u32 m0, s23, 1024
    s_nop 0
    buffer_load_dwordx4 v7, s[8:11], s19 offen lds
    s_add_u32 s19, s19, s20
    s_add_u32 s23, s23, 0x4000
    s_cmp_ge_u32 s23, 0x28000
    s_cbranch_scc0 1f
    s_sub_u32 s23, s23, 0x10000
    1:
    s_add_u32 m0, s23, 0
    s_nop 0
    buffer_load_dwordx4 v6, s[8:11], s19 offen lds
    s_add_u32 m0, s23, 1024
    s_nop 0
    buffer_load_dwordx4 v7, s[8:11], s19 offen lds
    s_add_u32 s19, s19, s20
    s_add_u32 s23, s23, 0x4000
    s_cmp_ge_u32 s23, 0x28000
    s_cbranch_scc0 1f
    s_sub_u32 s23, s23, 0x10000
    1:
    s_add_u32 m0, s22, 0
    s_nop 0
    buffer_load_dwordx4 v2, s[4:7], s18 offen sc1 lds
    s_add_u32 m0, s22, 1024
    s_nop 0
    buffer_load_dwordx4 v3, s[4:7], s18 offen sc1 lds
    s_add_u32 m0, s23, 0
    s_nop 0
    buffer_load_dwordx4 v6, s[8:11], s19 offen lds
    s_add_u32 m0, s23, 1024
    s_nop 0
    buffer_load_dwordx4 v7, s[8:11], s19 offen lds
    s_add_u32 s19, s19, s20
    s_add_u32 s23, s23, 0x4000
    s_cmp_ge_u32 s23, 0x28000
    s_cbranch_scc0 1f
    s_sub_u32 s23, s23, 0x10000
    1:
    s_add_u32 m0, s22, 2048
    s_nop 0
    buffer_load_dwordx4 v4, s[4:7], s18 offen sc1 lds
    s_add_u32 m0, s22, 3072
    s_nop 0
    buffer_load_dwordx4 v5, s[4:7], s18 offen sc1 lds
    s_add_u32 s18, s18, 128
    s_add_u32 s22, s22, 0x8000
    s_cmp_ge_u32 s22, 0x18000
    s_cbranch_scc0 1f
    s_sub_u32 s22, s22, 0x18000
    1:
    s_add_u32 m0, s23, 0
    s_nop 0
    buffer_load_dwordx4 v6, s[8:11], s19 offen lds
    s_add_u32 m0, s23, 1024
    s_nop 0
    buffer_load_dwordx4 v7, s[8:11], s19 offen lds
    s_add_u32 s19, s19, s20
    s_add_u32 s23, s23, 0x4000
    s_cmp_ge_u32 s23, 0x28000
    s_cbranch_scc0 1f
    s_sub_u32 s23, s23, 0x10000
    1:
    s_add_u32 m0, s22, 0
    s_nop 0
    buffer_load_dwordx4 v2, s[4:7], s18 offen sc1 lds
    s_add_u32 m0, s22, 1024
    s_nop 0
    buffer_load_dwordx4 v3, s[4:7], s18 offen sc1 lds
    v_lshrrev_b32 v204, 5, v1
    v_and_b32 v205, 31, v1
    v_add_u32 v205, s28, v205
    v_lshlrev_b32 v205, 7, v205
    v_bfe_u32 v206, v1, 1, 3
    v_add_u32 v207, 0, v204
    v_xor_b32 v207, v207, v206
    v_lshl_add_u32 v10, v207, 4, v205
    v_add_u32 v207, 2, v204
    v_xor_b32 v207, v207, v206
    v_lshl_add_u32 v11, v207, 4, v205
    v_add_u32 v207, 4, v204
    v_xor_b32 v207, v207, v206
    v_lshl_add_u32 v12, v207, 4, v205
    v_add_u32 v207, 6, v204
    v_xor_b32 v207, v207, v206
    v_lshl_add_u32 v13, v207, 4, v205
    v_bfe_u32 v205, v1, 2, 2
    v_lshlrev_b32 v206, 3, v204
    v_add_u32 v206, v206, v205
    v_lshlrev_b32 v206, 8, v206
    v_and_b32 v207, 1, v1
    v_lshl_add_u32 v206, v207, 3, v206
    v_add_u32 v206, 0x18000, v206
    v_bfe_u32 v207, v1, 4, 1
    v_lshlrev_b32 v207, 1, v207
    v_bfe_u32 v208, v1, 1, 1
    v_add_u32 v207, v207, v208
    v_lshlrev_b32 v205, 2, v205
    v_add_u32 v208, s33, v207
    v_xor_b32 v208, v208, v205
    v_lshl_add_u32 v208, v208, 4, v206
    v_add_u32 v14, s32, v208
    v_add_u32 v208, s35, v207
    v_xor_b32 v208, v208, v205
    v_lshl_add_u32 v208, v208, 4, v206
    v_add_u32 v15, s34, v208
    s_cmp_lt_u32 s61, 16
    s_cbranch_scc1 Ltq_1
    s_and_b32 s39, s21, 1
    s_cmp_eq_u32 s39, 0
    s_cselect_b32 s62, s52, s54
    s_cselect_b32 s63, s53, s55
    s_mov_b32 s64, s62
    s_and_b32 s65, s63, 0xffff
    s_mov_b32 s66, 2211840
    s_mov_b32 s67, 0x00020000
    v_lshrrev_b32 v195, 4, v1
    v_mul_u32_u24 v195, 3456, v195
    v_and_b32 v196, 15, v1
    v_lshl_add_u32 v195, v196, 4, v195
    s_lshr_b32 s39, s21, 1
    s_lshl_b32 s39, s39, 2
    s_mul_i32 s68, s37, 80
    s_add_u32 s68, s68, s39
    s_mul_i32 s68, s68, 3456
    s_sub_u32 s39, s61, 16
    s_lshl_b32 s39, s39, 8
    s_add_u32 s68, s68, s39
    s_mov_b32 s69, 55296
    s_branch Ltj_2
Ltq_1:
    s_mov_b32 s64, s44
    s_and_b32 s65, s45, 0xffff
    s_mov_b32 s66, 5242880
    s_mov_b32 s67, 0x00020000
    v_lshrrev_b32 v195, 5, v1
    v_lshlrev_b32 v195, 13, v195
    v_and_b32 v196, 31, v1
    v_lshl_add_u32 v195, v196, 4, v195
    s_lshl_b32 s39, s21, 1
    s_mul_i32 s68, s37, 80
    s_add_u32 s68, s68, s39
    s_lshl_b32 s68, s68, 13
    s_lshl_b32 s39, s61, 9
    s_add_u32 s68, s68, s39
    s_mov_b32 s69, 131072
Ltj_2:
    buffer_load_dwordx4 v[196:199], v195, s[64:67], s68 offen
    s_add_u32 s68, s68, s69
    v_mov_b32 v200, 0
    s_lshl_b32 s39, s2, 3
    s_add_u32 s39, s39, s21
    s_lshl_b32 s39, s39, 8
    s_add_u32 s39, s39, 117440512
    v_lshlrev_b32 v203, 2, v1
    buffer_store_dword v200, v203, s[12:15], s39 offen sc1
    v_mov_b32 v64, 0
    v_mov_b32 v65, 0
    v_mov_b32 v66, 0
    v_mov_b32 v67, 0
    v_mov_b32 v68, 0
    v_mov_b32 v69, 0
    v_mov_b32 v70, 0
    v_mov_b32 v71, 0
    v_mov_b32 v72, 0
    v_mov_b32 v73, 0
    v_mov_b32 v74, 0
    v_mov_b32 v75, 0
    v_mov_b32 v76, 0
    v_mov_b32 v77, 0
    v_mov_b32 v78, 0
    v_mov_b32 v79, 0
    v_mov_b32 v80, 0
    v_mov_b32 v81, 0
    v_mov_b32 v82, 0
    v_mov_b32 v83, 0
    v_mov_b32 v84, 0
    v_mov_b32 v85, 0
    v_mov_b32 v86, 0
    v_mov_b32 v87, 0
    v_mov_b32 v88, 0
    v_mov_b32 v89, 0
    v_mov_b32 v90, 0
    v_mov_b32 v91, 0
    v_mov_b32 v92, 0
    v_mov_b32 v93, 0
    v_mov_b32 v94, 0
    v_mov_b32 v95, 0
    v_mov_b32 v96, 0
    v_mov_b32 v97, 0
    v_mov_b32 v98, 0
    v_mov_b32 v99, 0
    v_mov_b32 v100, 0
    v_mov_b32 v101, 0
    v_mov_b32 v102, 0
    v_mov_b32 v103, 0
    v_mov_b32 v104, 0
    v_mov_b32 v105, 0
    v_mov_b32 v106, 0
    v_mov_b32 v107, 0
    v_mov_b32 v108, 0
    v_mov_b32 v109, 0
    v_mov_b32 v110, 0
    v_mov_b32 v111, 0
    v_mov_b32 v112, 0
    v_mov_b32 v113, 0
    v_mov_b32 v114, 0
    v_mov_b32 v115, 0
    v_mov_b32 v116, 0
    v_mov_b32 v117, 0
    v_mov_b32 v118, 0
    v_mov_b32 v119, 0
    v_mov_b32 v120, 0
    v_mov_b32 v121, 0
    v_mov_b32 v122, 0
    v_mov_b32 v123, 0
    v_mov_b32 v124, 0
    v_mov_b32 v125, 0
    v_mov_b32 v126, 0
    v_mov_b32 v127, 0
    v_mov_b32 v128, 0
    v_mov_b32 v129, 0
    v_mov_b32 v130, 0
    v_mov_b32 v131, 0
    v_mov_b32 v132, 0
    v_mov_b32 v133, 0
    v_mov_b32 v134, 0
    v_mov_b32 v135, 0
    v_mov_b32 v136, 0
    v_mov_b32 v137, 0
    v_mov_b32 v138, 0
    v_mov_b32 v139, 0
    v_mov_b32 v140, 0
    v_mov_b32 v141, 0
    v_mov_b32 v142, 0
    v_mov_b32 v143, 0
    v_mov_b32 v144, 0
    v_mov_b32 v145, 0
    v_mov_b32 v146, 0
    v_mov_b32 v147, 0
    v_mov_b32 v148, 0
    v_mov_b32 v149, 0
    v_mov_b32 v150, 0
    v_mov_b32 v151, 0
    v_mov_b32 v152, 0
    v_mov_b32 v153, 0
    v_mov_b32 v154, 0
    v_mov_b32 v155, 0
    v_mov_b32 v156, 0
    v_mov_b32 v157, 0
    v_mov_b32 v158, 0
    v_mov_b32 v159, 0
    v_mov_b32 v160, 0
    v_mov_b32 v161, 0
    v_mov_b32 v162, 0
    v_mov_b32 v163, 0
    v_mov_b32 v164, 0
    v_mov_b32 v165, 0
    v_mov_b32 v166, 0
    v_mov_b32 v167, 0
    v_mov_b32 v168, 0
    v_mov_b32 v169, 0
    v_mov_b32 v170, 0
    v_mov_b32 v171, 0
    v_mov_b32 v172, 0
    v_mov_b32 v173, 0
    v_mov_b32 v174, 0
    v_mov_b32 v175, 0
    v_mov_b32 v176, 0
    v_mov_b32 v177, 0
    v_mov_b32 v178, 0
    v_mov_b32 v179, 0
    v_mov_b32 v180, 0
    v_mov_b32 v181, 0
    v_mov_b32 v182, 0
    v_mov_b32 v183, 0
    v_mov_b32 v184, 0
    v_mov_b32 v185, 0
    v_mov_b32 v186, 0
    v_mov_b32 v187, 0
    v_mov_b32 v188, 0
    v_mov_b32 v189, 0
    v_mov_b32 v190, 0
    v_mov_b32 v191, 0
    s_mov_b32 s40, s50
    s_and_b32 s41, s51, 0xffff
    s_mov_b32 s42, 256
    s_mov_b32 s43, 0x00020000
    v_and_b32 v204, 7, v1
    v_lshlrev_b32 v204, 5, v204
    s_waitcnt vmcnt(20)
    v_lshlrev_b32 v215, 16, v210
    v_and_b32 v216, 0xffff0000, v210
    v_lshlrev_b32 v217, 16, v211
    v_and_b32 v218, 0xffff0000, v211
    v_lshlrev_b32 v219, 16, v212
    v_and_b32 v220, 0xffff0000, v212
    v_lshlrev_b32 v221, 16, v213
    v_and_b32 v222, 0xffff0000, v213
    v_lshlrev_b32 v223, 16, v214
    v_and_b32 v224, 0xffff0000, v214
    v_add_f32 v229, v215, v216
    v_add_f32 v229, v229, v217
    v_add_f32 v229, v229, v218
    v_add_f32 v229, v229, v219
    v_add_f32 v229, v229, v220
    v_add_f32 v229, v229, v221
    v_add_f32 v229, v229, v222
    v_add_f32 v229, v229, v223
    v_add_f32 v229, v229, v224
    s_nop 1
    v_add_f32_dpp v229, v229, v229 quad_perm:[1,0,3,2] row_mask:0xf bank_mask:0xf
    s_nop 1
    v_add_f32_dpp v229, v229, v229 quad_perm:[2,3,0,1] row_mask:0xf bank_mask:0xf
    s_nop 1
    v_add_f32_dpp v229, v229, v229 row_half_mirror row_mask:0xf bank_mask:0xf
    s_nop 1
    v_add_f32_dpp v229, v229, v229 row_mirror row_mask:0xf bank_mask:0xf
    v_mov_b32 v225, v229
    s_nop 1
    v_permlane16_swap_b32 v225, v229
    s_nop 1
    v_add_f32 v229, v229, v225
    v_mov_b32 v225, v229
    s_nop 1
    v_permlane32_swap_b32 v225, v229
    s_nop 1
    v_add_f32 v229, v229, v225
    v_mul_f32 v229, 0x3acccccd, v229
    v_sub_f32 v225, v215, v229
    v_mul_f32 v227, v225, v225
    v_sub_f32 v225, v216, v229
    v_fmac_f32 v227, v225, v225
    v_sub_f32 v225, v217, v229
    v_fmac_f32 v227, v225, v225
    v_sub_f32 v225, v218, v229
    v_fmac_f32 v227, v225, v225
    v_sub_f32 v225, v219, v229
    v_fmac_f32 v227, v225, v225
    v_sub_f32 v225, v220, v229
    v_fmac_f32 v227, v225, v225
    v_sub_f32 v225, v221, v229
    v_fmac_f32 v227, v225, v225
    v_sub_f32 v225, v222, v229
    v_fmac_f32 v227, v225, v225
    v_sub_f32 v225, v223, v229
    v_fmac_f32 v227, v225, v225
    v_sub_f32 v225, v224, v229
    v_fmac_f32 v227, v225, v225
    s_nop 1
    v_add_f32_dpp v227, v227, v227 quad_perm:[1,0,3,2] row_mask:0xf bank_mask:0xf
    s_nop 1
    v_add_f32_dpp v227, v227, v227 quad_perm:[2,3,0,1] row_mask:0xf bank_mask:0xf
    s_nop 1
    v_add_f32_dpp v227, v227, v227 row_half_mirror row_mask:0xf bank_mask:0xf
    s_nop 1
    v_add_f32_dpp v227, v227, v227 row_mirror row_mask:0xf bank_mask:0xf
    v_mov_b32 v225, v227
    s_nop 1
    v_permlane16_swap_b32 v225, v227
    s_nop 1
    v_add_f32 v227, v227, v225
    v_mov_b32 v225, v227
    s_nop 1
    v_permlane32_swap_b32 v225, v227
    s_nop 1
    v_add_f32 v227, v227, v225
    v_mul_f32 v227, 0x3acccccd, v227
    v_cvt_pk_bf16_f32 v225, v229, v227
    v_lshlrev_b32 v229, 16, v225
    v_and_b32 v227, 0xffff0000, v225
    v_add_f32 v227, 0x3727c5ac, v227
    v_cvt_pk_bf16_f32 v227, v227, v227
    v_and_b32 v227, 0xffff0000, v227
    v_sqrt_f32 v227, v227
    s_nop 0
    v_cvt_pk_bf16_f32 v227, v227, v227
    v_and_b32 v227, 0xffff0000, v227
    v_rcp_f32 v227, v227
    v_sub_f32 v215, v215, v229
    v_sub_f32 v216, v216, v229
    v_cvt_pk_bf16_f32 v210, v215, v216
    v_lshlrev_b32 v215, 16, v210
    v_and_b32 v216, 0xffff0000, v210
    v_mul_f32 v215, v215, v227
    v_mul_f32 v216, v216, v227
    v_cvt_pk_bf16_f32 v210, v215, v216
    buffer_store_dword v210, v228, s[12:15], s17 offen offset:0 sc1
    v_sub_f32 v217, v217, v229
    v_sub_f32 v218, v218, v229
    v_cvt_pk_bf16_f32 v211, v217, v218
    v_lshlrev_b32 v217, 16, v211
    v_and_b32 v218, 0xffff0000, v211
    v_mul_f32 v217, v217, v227
    v_mul_f32 v218, v218, v227
    v_cvt_pk_bf16_f32 v211, v217, v218
    buffer_store_dword v211, v228, s[12:15], s17 offen offset:256 sc1
    v_sub_f32 v219, v219, v229
    v_sub_f32 v220, v220, v229
    v_cvt_pk_bf16_f32 v212, v219, v220
    v_lshlrev_b32 v219, 16, v212
    v_and_b32 v220, 0xffff0000, v212
    v_mul_f32 v219, v219, v227
    v_mul_f32 v220, v220, v227
    v_cvt_pk_bf16_f32 v212, v219, v220
    buffer_store_dword v212, v228, s[12:15], s17 offen offset:512 sc1
    v_sub_f32 v221, v221, v229
    v_sub_f32 v222, v222, v229
    v_cvt_pk_bf16_f32 v213, v221, v222
    v_lshlrev_b32 v221, 16, v213
    v_and_b32 v222, 0xffff0000, v213
    v_mul_f32 v221, v221, v227
    v_mul_f32 v222, v222, v227
    v_cvt_pk_bf16_f32 v213, v221, v222
    buffer_store_dword v213, v228, s[12:15], s17 offen offset:768 sc1
    v_sub_f32 v223, v223, v229
    v_sub_f32 v224, v224, v229
    v_cvt_pk_bf16_f32 v214, v223, v224
    v_lshlrev_b32 v223, 16, v214
    v_and_b32 v224, 0xffff0000, v214
    v_mul_f32 v223, v223, v227
    v_mul_f32 v224, v224, v227
    v_cvt_pk_bf16_f32 v214, v223, v224
    buffer_store_dword v214, v228, s[12:15], s17 offen offset:1024 sc1
    v_mov_b32 v200, 0
    v_mov_b32 v201, 0
    s_waitcnt vmcnt(19)
    s_barrier
    ds_read_b64_tr_b16 v[32:33], v14 offset:0
    ds_read_b64_tr_b16 v[34:35], v14 offset:1024
    ds_read_b64_tr_b16 v[36:37], v15 offset:0
    ds_read_b64_tr_b16 v[38:39], v15 offset:1024
    ds_read_b128 v[16:19], v10 offset:0
    ds_read_b128 v[20:23], v10 offset:4096
    ds_read_b128 v[24:27], v10 offset:8192
    ds_read_b128 v[28:31], v10 offset:12288
    v_lshlrev_b32 v220, 4, v1
    s_cmp_eq_u32 s30, 2
    s_cbranch_scc1 Lv_3
Lk_6:
    s_waitcnt lgkmcnt(0)
    v_mfma_f32_32x32x16_bf16 v[64:79], v[32:35], v[16:19], v[64:79]
    ds_read_b64_tr_b16 v[56:57], v14 offset:4096
    ds_read_b64_tr_b16 v[58:59], v14 offset:5120
    v_mfma_f32_32x32x16_bf16 v[80:95], v[36:39], v[16:19], v[80:95]
    ds_read_b64_tr_b16 v[60:61], v15 offset:4096
    ds_read_b64_tr_b16 v[62:63], v15 offset:5120
    v_mfma_f32_32x32x16_bf16 v[96:111], v[32:35], v[20:23], v[96:111]
    ds_read_b128 v[40:43], v11 offset:0
    ds_read_b128 v[44:47], v11 offset:4096
    v_mfma_f32_32x32x16_bf16 v[112:127], v[36:39], v[20:23], v[112:127]
    ds_read_b128 v[48:51], v11 offset:8192
    ds_read_b128 v[52:55], v11 offset:12288
    v_mfma_f32_32x32x16_bf16 v[128:143], v[32:35], v[24:27], v[128:143]
    v_mfma_f32_32x32x16_bf16 v[144:159], v[36:39], v[24:27], v[144:159]
    v_mfma_f32_32x32x16_bf16 v[160:175], v[32:35], v[28:31], v[160:175]
    v_mfma_f32_32x32x16_bf16 v[176:191], v[36:39], v[28:31], v[176:191]
    s_waitcnt vmcnt(9) lgkmcnt(0)
    s_barrier
    s_cmp_eq_u32 s16, 2
    s_cbranch_scc1 Lhook_5_b
Lhook_5_q0:
    v_mfma_f32_32x32x16_bf16 v[64:79], v[56:59], v[40:43], v[64:79]
    ds_read_b64_tr_b16 v[32:33], v14 offset:16384
    ds_read_b64_tr_b16 v[34:35], v14 offset:17408
    v_mfma_f32_32x32x16_bf16 v[80:95], v[60:63], v[40:43], v[80:95]
    ds_read_b64_tr_b16 v[36:37], v15 offset:16384
    ds_read_b64_tr_b16 v[38:39], v15 offset:17408
    v_mfma_f32_32x32x16_bf16 v[96:111], v[56:59], v[44:47], v[96:111]
    ds_read_b128 v[16:19], v12 offset:0
    ds_read_b128 v[20:23], v12 offset:4096
    v_mfma_f32_32x32x16_bf16 v[112:127], v[60:63], v[44:47], v[112:127]
    ds_read_b128 v[24:27], v12 offset:8192
    ds_read_b128 v[28:31], v12 offset:12288
    v_mfma_f32_32x32x16_bf16 v[128:143], v[56:59], v[48:51], v[128:143]
    s_add_u32 m0, s23, 0
    s_nop 0
    buffer_load_dwordx4 v6, s[8:11], s19 offen lds
    v_mfma_f32_32x32x16_bf16 v[144:159], v[60:63], v[48:51], v[144:159]
    s_add_u32 m0, s23, 1024
    s_nop 0
    buffer_load_dwordx4 v7, s[8:11], s19 offen lds
    s_add_u32 s19, s19, s20
    s_add_u32 s23, s23, 0x4000
    s_cmp_ge_u32 s23, 0x28000
    s_cbranch_scc0 1f
    s_sub_u32 s23, s23, 0x10000
    1:
    v_mfma_f32_32x32x16_bf16 v[160:175], v[56:59], v[52:55], v[160:175]
    s_add_u32 m0, s22, 2048
    s_nop 0
    buffer_load_dwordx4 v4, s[4:7], s18 offen sc1 lds
    v_mfma_f32_32x32x16_bf16 v[176:191], v[60:63], v[52:55], v[176:191]
    s_add_u32 m0, s22, 3072
    s_nop 0
    buffer_load_dwordx4 v5, s[4:7], s18 offen sc1 lds
    s_add_u32 s18, s18, 128
    s_add_u32 s22, s22, 0x8000
    s_cmp_ge_u32 s22, 0x18000
    s_cbranch_scc0 1f
    s_sub_u32 s22, s22, 0x18000
    1:
    s_waitcnt lgkmcnt(0)
    v_mfma_f32_32x32x16_bf16 v[64:79], v[32:35], v[16:19], v[64:79]
    ds_read_b64_tr_b16 v[56:57], v14 offset:20480
    ds_read_b64_tr_b16 v[58:59], v14 offset:21504
    v_mfma_f32_32x32x16_bf16 v[80:95], v[36:39], v[16:19], v[80:95]
    ds_read_b64_tr_b16 v[60:61], v15 offset:20480
    ds_read_b64_tr_b16 v[62:63], v15 offset:21504
    v_mfma_f32_32x32x16_bf16 v[96:111], v[32:35], v[20:23], v[96:111]
    ds_read_b128 v[40:43], v13 offset:0
    ds_read_b128 v[44:47], v13 offset:4096
    v_mfma_f32_32x32x16_bf16 v[112:127], v[36:39], v[20:23], v[112:127]
    ds_read_b128 v[48:51], v13 offset:8192
    ds_read_b128 v[52:55], v13 offset:12288
    v_mfma_f32_32x32x16_bf16 v[128:143], v[32:35], v[24:27], v[128:143]
    s_add_u32 s27, s27, 1
    s_cmp_eq_u32 s27, 3
    s_cselect_b32 s27, 0, s27
    s_cselect_b32 s26, s70, s71
    v_mfma_f32_32x32x16_bf16 v[144:159], v[36:39], v[24:27], v[144:159]
    v_mfma_f32_32x32x16_bf16 v[160:175], v[32:35], v[28:31], v[160:175]
    v_mfma_f32_32x32x16_bf16 v[176:191], v[36:39], v[28:31], v[176:191]
    s_waitcnt vmcnt(9) lgkmcnt(0)
    s_barrier
    s_branch Lhook_5
Lhook_5_r0:
    v_add_u32 v10, s26, v10
    v_add_u32 v11, s26, v11
    v_add_u32 v12, s26, v12
    v_add_u32 v13, s26, v13
    v_xor_b32 v14, 0x38000, v14
    v_xor_b32 v15, 0x38000, v15
    v_mfma_f32_32x32x16_bf16 v[64:79], v[56:59], v[40:43], v[64:79]
    ds_read_b64_tr_b16 v[32:33], v14 offset:0
    ds_read_b64_tr_b16 v[34:35], v14 offset:1024
    v_mfma_f32_32x32x16_bf16 v[80:95], v[60:63], v[40:43], v[80:95]
    ds_read_b64_tr_b16 v[36:37], v15 offset:0
    ds_read_b64_tr_b16 v[38:39], v15 offset:1024
    v_mfma_f32_32x32x16_bf16 v[96:111], v[56:59], v[44:47], v[96:111]
    ds_read_b128 v[16:19], v10 offset:0
    ds_read_b128 v[20:23], v10 offset:4096
    v_mfma_f32_32x32x16_bf16 v[112:127], v[60:63], v[44:47], v[112:127]
    ds_read_b128 v[24:27], v10 offset:8192
    ds_read_b128 v[28:31], v10 offset:12288
    v_mfma_f32_32x32x16_bf16 v[128:143], v[56:59], v[48:51], v[128:143]
    s_add_u32 m0, s23, 0
    s_nop 0
    buffer_load_dwordx4 v6, s[8:11], s19 offen lds
    v_mfma_f32_32x32x16_bf16 v[144:159], v[60:63], v[48:51], v[144:159]
    s_add_u32 m0, s23, 1024
    s_nop 0
    buffer_load_dwordx4 v7, s[8:11], s19 offen lds
    s_add_u32 s19, s19, s20
    s_add_u32 s23, s23, 0x4000
    s_cmp_ge_u32 s23, 0x28000
    s_cbranch_scc0 1f
    s_sub_u32 s23, s23, 0x10000
    1:
    v_mfma_f32_32x32x16_bf16 v[160:175], v[56:59], v[52:55], v[160:175]
    s_add_u32 m0, s22, 0
    s_nop 0
    buffer_load_dwordx4 v2, s[4:7], s18 offen sc1 lds
    v_mfma_f32_32x32x16_bf16 v[176:191], v[60:63], v[52:55], v[176:191]
    s_add_u32 m0, s22, 1024
    s_nop 0
    buffer_load_dwordx4 v3, s[4:7], s18 offen sc1 lds
    buffer_load_dwordx4 v[196:199], v195, s[64:67], s68 offen
    s_add_u32 s68, s68, s69
    s_sub_u32 s16, s16, 1
    s_cmp_lg_u32 s16, 0
    s_cbranch_scc1 Lk_6
    s_nop 7
    s_nop 7
    s_mov_b32 s31, 20971520
    s_lshl_b32 s32, s38, 13
    s_mov_b32 s34, s32
    s_bfe_u32 s39, s21, 0x10001
    s_lshl_b32 s33, s39, 3
    s_add_u32 s35, s33, 4
    s_lshl_b32 s39, s36, 1
    s_add_u32 s39, s39, s38
    s_lshl_b32 s39, s39, 19
    s_add_u32 s31, s31, s39
    s_lshl_b32 s39, s37, 8
    s_add_u32 s39, s39, s28
    s_lshl_b32 s39, s39, 8
    s_add_u32 s31, s31, s39
    s_lshl_b32 s39, s33, 9
    s_add_u32 s31, s31, s39
    v_mul_f32 v64, 0x3e0293ee, v64
    v_mul_f32 v65, 0x3e0293ee, v65
    v_mul_f32 v66, 0x3e0293ee, v66
    v_mul_f32 v67, 0x3e0293ee, v67
    v_mul_f32 v68, 0x3e0293ee, v68
    v_mul_f32 v69, 0x3e0293ee, v69
    v_mul_f32 v70, 0x3e0293ee, v70
    v_mul_f32 v71, 0x3e0293ee, v71
    v_mul_f32 v72, 0x3e0293ee, v72
    v_mul_f32 v73, 0x3e0293ee, v73
    v_mul_f32 v74, 0x3e0293ee, v74
    v_mul_f32 v75, 0x3e0293ee, v75
    v_mul_f32 v76, 0x3e0293ee, v76
    v_mul_f32 v77, 0x3e0293ee, v77
    v_mul_f32 v78, 0x3e0293ee, v78
    v_mul_f32 v79, 0x3e0293ee, v79
    v_cvt_pk_bf16_f32 v224, v64, v65
    v_cvt_pk_bf16_f32 v225, v66, v67
    v_cvt_pk_bf16_f32 v226, v68, v69
    v_cvt_pk_bf16_f32 v227, v70, v71
    buffer_store_dwordx4 v[224:227], v220, s[12:15], s31 offen offset:0 sc1
    v_mov_b32 v64, 0
    v_mov_b32 v65, 0
    v_mov_b32 v66, 0
    v_mov_b32 v67, 0
    v_mov_b32 v68, 0
    v_mov_b32 v69, 0
    v_mov_b32 v70, 0
    v_mov_b32 v71, 0
    v_cvt_pk_bf16_f32 v228, v72, v73
    v_cvt_pk_bf16_f32 v229, v74, v75
    v_cvt_pk_bf16_f32 v230, v76, v77
    v_cvt_pk_bf16_f32 v231, v78, v79
    buffer_store_dwordx4 v[228:231], v220, s[12:15], s31 offen offset:1024 sc1
    v_mov_b32 v72, 0
    v_mov_b32 v73, 0
    v_mov_b32 v74, 0
    v_mov_b32 v75, 0
    v_mov_b32 v76, 0
    v_mov_b32 v77, 0
    v_mov_b32 v78, 0
    v_mov_b32 v79, 0
    v_mul_f32 v80, 0x3e0293ee, v80
    v_mul_f32 v81, 0x3e0293ee, v81
    v_mul_f32 v82, 0x3e0293ee, v82
    v_mul_f32 v83, 0x3e0293ee, v83
    v_mul_f32 v84, 0x3e0293ee, v84
    v_mul_f32 v85, 0x3e0293ee, v85
    v_mul_f32 v86, 0x3e0293ee, v86
    v_mul_f32 v87, 0x3e0293ee, v87
    v_mul_f32 v88, 0x3e0293ee, v88
    v_mul_f32 v89, 0x3e0293ee, v89
    v_mul_f32 v90, 0x3e0293ee, v90
    v_mul_f32 v91, 0x3e0293ee, v91
    v_mul_f32 v92, 0x3e0293ee, v92
    v_mul_f32 v93, 0x3e0293ee, v93
    v_mul_f32 v94, 0x3e0293ee, v94
    v_mul_f32 v95, 0x3e0293ee, v95
    v_cvt_pk_bf16_f32 v232, v80, v81
    v_cvt_pk_bf16_f32 v233, v82, v83
    v_cvt_pk_bf16_f32 v234, v84, v85
    v_cvt_pk_bf16_f32 v235, v86, v87
    buffer_store_dwordx4 v[232:235], v220, s[12:15], s31 offen offset:2048 sc1
    v_mov_b32 v80, 0
    v_mov_b32 v81, 0
    v_mov_b32 v82, 0
    v_mov_b32 v83, 0
    v_mov_b32 v84, 0
    v_mov_b32 v85, 0
    v_mov_b32 v86, 0
    v_mov_b32 v87, 0
    v_cvt_pk_bf16_f32 v236, v88, v89
    v_cvt_pk_bf16_f32 v237, v90, v91
    v_cvt_pk_bf16_f32 v238, v92, v93
    v_cvt_pk_bf16_f32 v239, v94, v95
    buffer_store_dwordx4 v[236:239], v220, s[12:15], s31 offen offset:3072 sc1
    v_mov_b32 v88, 0
    v_mov_b32 v89, 0
    v_mov_b32 v90, 0
    v_mov_b32 v91, 0
    v_mov_b32 v92, 0
    v_mov_b32 v93, 0
    v_mov_b32 v94, 0
    v_mov_b32 v95, 0
    s_add_u32 s31, s31, 8192
    v_mul_f32 v96, 0x3e0293ee, v96
    v_mul_f32 v97, 0x3e0293ee, v97
    v_mul_f32 v98, 0x3e0293ee, v98
    v_mul_f32 v99, 0x3e0293ee, v99
    v_mul_f32 v100, 0x3e0293ee, v100
    v_mul_f32 v101, 0x3e0293ee, v101
    v_mul_f32 v102, 0x3e0293ee, v102
    v_mul_f32 v103, 0x3e0293ee, v103
    v_mul_f32 v104, 0x3e0293ee, v104
    v_mul_f32 v105, 0x3e0293ee, v105
    v_mul_f32 v106, 0x3e0293ee, v106
    v_mul_f32 v107, 0x3e0293ee, v107
    v_mul_f32 v108, 0x3e0293ee, v108
    v_mul_f32 v109, 0x3e0293ee, v109
    v_mul_f32 v110, 0x3e0293ee, v110
    v_mul_f32 v111, 0x3e0293ee, v111
    v_cvt_pk_bf16_f32 v224, v96, v97
    v_cvt_pk_bf16_f32 v225, v98, v99
    v_cvt_pk_bf16_f32 v226, v100, v101
    v_cvt_pk_bf16_f32 v227, v102, v103
    buffer_store_dwordx4 v[224:227], v220, s[12:15], s31 offen offset:0 sc1
    v_mov_b32 v96, 0
    v_mov_b32 v97, 0
    v_mov_b32 v98, 0
    v_mov_b32 v99, 0
    v_mov_b32 v100, 0
    v_mov_b32 v101, 0
    v_mov_b32 v102, 0
    v_mov_b32 v103, 0
    v_cvt_pk_bf16_f32 v228, v104, v105
    v_cvt_pk_bf16_f32 v229, v106, v107
    v_cvt_pk_bf16_f32 v230, v108, v109
    v_cvt_pk_bf16_f32 v231, v110, v111
    buffer_store_dwordx4 v[228:231], v220, s[12:15], s31 offen offset:1024 sc1
    v_mov_b32 v104, 0
    v_mov_b32 v105, 0
    v_mov_b32 v106, 0
    v_mov_b32 v107, 0
    v_mov_b32 v108, 0
    v_mov_b32 v109, 0
    v_mov_b32 v110, 0
    v_mov_b32 v111, 0
    v_mul_f32 v112, 0x3e0293ee, v112
    v_mul_f32 v113, 0x3e0293ee, v113
    v_mul_f32 v114, 0x3e0293ee, v114
    v_mul_f32 v115, 0x3e0293ee, v115
    v_mul_f32 v116, 0x3e0293ee, v116
    v_mul_f32 v117, 0x3e0293ee, v117
    v_mul_f32 v118, 0x3e0293ee, v118
    v_mul_f32 v119, 0x3e0293ee, v119
    v_mul_f32 v120, 0x3e0293ee, v120
    v_mul_f32 v121, 0x3e0293ee, v121
    v_mul_f32 v122, 0x3e0293ee, v122
    v_mul_f32 v123, 0x3e0293ee, v123
    v_mul_f32 v124, 0x3e0293ee, v124
    v_mul_f32 v125, 0x3e0293ee, v125
    v_mul_f32 v126, 0x3e0293ee, v126
    v_mul_f32 v127, 0x3e0293ee, v127
    v_cvt_pk_bf16_f32 v232, v112, v113
    v_cvt_pk_bf16_f32 v233, v114, v115
    v_cvt_pk_bf16_f32 v234, v116, v117
    v_cvt_pk_bf16_f32 v235, v118, v119
    buffer_store_dwordx4 v[232:235], v220, s[12:15], s31 offen offset:2048 sc1
    v_mov_b32 v112, 0
    v_mov_b32 v113, 0
    v_mov_b32 v114, 0
    v_mov_b32 v115, 0
    v_mov_b32 v116, 0
    v_mov_b32 v117, 0
    v_mov_b32 v118, 0
    v_mov_b32 v119, 0
    v_cvt_pk_bf16_f32 v236, v120, v121
    v_cvt_pk_bf16_f32 v237, v122, v123
    v_cvt_pk_bf16_f32 v238, v124, v125
    v_cvt_pk_bf16_f32 v239, v126, v127
    buffer_store_dwordx4 v[236:239], v220, s[12:15], s31 offen offset:3072 sc1
    v_mov_b32 v120, 0
    v_mov_b32 v121, 0
    v_mov_b32 v122, 0
    v_mov_b32 v123, 0
    v_mov_b32 v124, 0
    v_mov_b32 v125, 0
    v_mov_b32 v126, 0
    v_mov_b32 v127, 0
    s_add_u32 s31, s31, 8192
    v_mul_f32 v128, 0x3e0293ee, v128
    v_mul_f32 v129, 0x3e0293ee, v129
    v_mul_f32 v130, 0x3e0293ee, v130
    v_mul_f32 v131, 0x3e0293ee, v131
    v_mul_f32 v132, 0x3e0293ee, v132
    v_mul_f32 v133, 0x3e0293ee, v133
    v_mul_f32 v134, 0x3e0293ee, v134
    v_mul_f32 v135, 0x3e0293ee, v135
    v_mul_f32 v136, 0x3e0293ee, v136
    v_mul_f32 v137, 0x3e0293ee, v137
    v_mul_f32 v138, 0x3e0293ee, v138
    v_mul_f32 v139, 0x3e0293ee, v139
    v_mul_f32 v140, 0x3e0293ee, v140
    v_mul_f32 v141, 0x3e0293ee, v141
    v_mul_f32 v142, 0x3e0293ee, v142
    v_mul_f32 v143, 0x3e0293ee, v143
    s_add_u32 s64, s31, 0
    s_nop 0
    v_cvt_pk_bf16_f32 v224, v128, v129
    v_cvt_pk_bf16_f32 v225, v130, v131
    v_cvt_pk_bf16_f32 v226, v132, v133
    v_cvt_pk_bf16_f32 v227, v134, v135
    v_cvt_pk_bf16_f32 v228, v136, v137
    v_cvt_pk_bf16_f32 v229, v138, v139
    v_cvt_pk_bf16_f32 v230, v140, v141
    v_cvt_pk_bf16_f32 v231, v142, v143
    v_mov_b32 v128, 0
    v_mov_b32 v129, 0
    v_mov_b32 v130, 0
    v_mov_b32 v131, 0
    v_mov_b32 v132, 0
    v_mov_b32 v133, 0
    v_mov_b32 v134, 0
    v_mov_b32 v135, 0
    v_mov_b32 v136, 0
    v_mov_b32 v137, 0
    v_mov_b32 v138, 0
    v_mov_b32 v139, 0
    v_mov_b32 v140, 0
    v_mov_b32 v141, 0
    v_mov_b32 v142, 0
    v_mov_b32 v143, 0
    v_mul_f32 v144, 0x3e0293ee, v144
    v_mul_f32 v145, 0x3e0293ee, v145
    v_mul_f32 v146, 0x3e0293ee, v146
    v_mul_f32 v147, 0x3e0293ee, v147
    v_mul_f32 v148, 0x3e0293ee, v148
    v_mul_f32 v149, 0x3e0293ee, v149
    v_mul_f32 v150, 0x3e0293ee, v150
    v_mul_f32 v151, 0x3e0293ee, v151
    v_mul_f32 v152, 0x3e0293ee, v152
    v_mul_f32 v153, 0x3e0293ee, v153
    v_mul_f32 v154, 0x3e0293ee, v154
    v_mul_f32 v155, 0x3e0293ee, v155
    v_mul_f32 v156, 0x3e0293ee, v156
    v_mul_f32 v157, 0x3e0293ee, v157
    v_mul_f32 v158, 0x3e0293ee, v158
    v_mul_f32 v159, 0x3e0293ee, v159
    s_add_u32 s65, s31, 2048
    s_nop 0
    v_cvt_pk_bf16_f32 v232, v144, v145
    v_cvt_pk_bf16_f32 v233, v146, v147
    v_cvt_pk_bf16_f32 v234, v148, v149
    v_cvt_pk_bf16_f32 v235, v150, v151
    v_cvt_pk_bf16_f32 v236, v152, v153
    v_cvt_pk_bf16_f32 v237, v154, v155
    v_cvt_pk_bf16_f32 v238, v156, v157
    v_cvt_pk_bf16_f32 v239, v158, v159
    v_mov_b32 v144, 0
    v_mov_b32 v145, 0
    v_mov_b32 v146, 0
    v_mov_b32 v147, 0
    v_mov_b32 v148, 0
    v_mov_b32 v149, 0
    v_mov_b32 v150, 0
    v_mov_b32 v151, 0
    v_mov_b32 v152, 0
    v_mov_b32 v153, 0
    v_mov_b32 v154, 0
    v_mov_b32 v155, 0
    v_mov_b32 v156, 0
    v_mov_b32 v157, 0
    v_mov_b32 v158, 0
    v_mov_b32 v159, 0
    s_add_u32 s31, s31, 8192
    v_mul_f32 v160, 0x3e0293ee, v160
    v_mul_f32 v161, 0x3e0293ee, v161
    v_mul_f32 v162, 0x3e0293ee, v162
    v_mul_f32 v163, 0x3e0293ee, v163
    v_mul_f32 v164, 0x3e0293ee, v164
    v_mul_f32 v165, 0x3e0293ee, v165
    v_mul_f32 v166, 0x3e0293ee, v166
    v_mul_f32 v167, 0x3e0293ee, v167
    v_mul_f32 v168, 0x3e0293ee, v168
    v_mul_f32 v169, 0x3e0293ee, v169
    v_mul_f32 v170, 0x3e0293ee, v170
    v_mul_f32 v171, 0x3e0293ee, v171
    v_mul_f32 v172, 0x3e0293ee, v172
    v_mul_f32 v173, 0x3e0293ee, v173
    v_mul_f32 v174, 0x3e0293ee, v174
    v_mul_f32 v175, 0x3e0293ee, v175
    s_add_u32 s66, s31, 0
    s_nop 0
    v_cvt_pk_bf16_f32 v240, v160, v161
    v_cvt_pk_bf16_f32 v241, v162, v163
    v_cvt_pk_bf16_f32 v242, v164, v165
    v_cvt_pk_bf16_f32 v243, v166, v167
    v_cvt_pk_bf16_f32 v244, v168, v169
    v_cvt_pk_bf16_f32 v245, v170, v171
    v_cvt_pk_bf16_f32 v246, v172, v173
    v_cvt_pk_bf16_f32 v247, v174, v175
    v_mov_b32 v160, 0
    v_mov_b32 v161, 0
    v_mov_b32 v162, 0
    v_mov_b32 v163, 0
    v_mov_b32 v164, 0
    v_mov_b32 v165, 0
    v_mov_b32 v166, 0
    v_mov_b32 v167, 0
    v_mov_b32 v168, 0
    v_mov_b32 v169, 0
    v_mov_b32 v170, 0
    v_mov_b32 v171, 0
    v_mov_b32 v172, 0
    v_mov_b32 v173, 0
    v_mov_b32 v174, 0
    v_mov_b32 v175, 0
    v_mul_f32 v176, 0x3e0293ee, v176
    v_mul_f32 v177, 0x3e0293ee, v177
    v_mul_f32 v178, 0x3e0293ee, v178
    v_mul_f32 v179, 0x3e0293ee, v179
    v_mul_f32 v180, 0x3e0293ee, v180
    v_mul_f32 v181, 0x3e0293ee, v181
    v_mul_f32 v182, 0x3e0293ee, v182
    v_mul_f32 v183, 0x3e0293ee, v183
    v_mul_f32 v184, 0x3e0293ee, v184
    v_mul_f32 v185, 0x3e0293ee, v185
    v_mul_f32 v186, 0x3e0293ee, v186
    v_mul_f32 v187, 0x3e0293ee, v187
    v_mul_f32 v188, 0x3e0293ee, v188
    v_mul_f32 v189, 0x3e0293ee, v189
    v_mul_f32 v190, 0x3e0293ee, v190
    v_mul_f32 v191, 0x3e0293ee, v191
    s_add_u32 s67, s31, 2048
    s_nop 0
    v_cvt_pk_bf16_f32 v248, v176, v177
    v_cvt_pk_bf16_f32 v249, v178, v179
    v_cvt_pk_bf16_f32 v250, v180, v181
    v_cvt_pk_bf16_f32 v251, v182, v183
    v_cvt_pk_bf16_f32 v252, v184, v185
    v_cvt_pk_bf16_f32 v253, v186, v187
    v_cvt_pk_bf16_f32 v254, v188, v189
    v_cvt_pk_bf16_f32 v255, v190, v191
    v_mov_b32 v176, 0
    v_mov_b32 v177, 0
    v_mov_b32 v178, 0
    v_mov_b32 v179, 0
    v_mov_b32 v180, 0
    v_mov_b32 v181, 0
    v_mov_b32 v182, 0
    v_mov_b32 v183, 0
    v_mov_b32 v184, 0
    v_mov_b32 v185, 0
    v_mov_b32 v186, 0
    v_mov_b32 v187, 0
    v_mov_b32 v188, 0
    v_mov_b32 v189, 0
    v_mov_b32 v190, 0
    v_mov_b32 v191, 0
    s_add_u32 s31, s31, 8192
    s_branch Lt2_4
Lv_3:
Lk_7:
    s_waitcnt lgkmcnt(0)
    v_mfma_f32_32x32x16_bf16 v[64:79], v[16:19], v[32:35], v[64:79]
    ds_read_b64_tr_b16 v[56:57], v14 offset:4096
    ds_read_b64_tr_b16 v[58:59], v14 offset:5120
    v_mfma_f32_32x32x16_bf16 v[80:95], v[16:19], v[36:39], v[80:95]
    ds_read_b64_tr_b16 v[60:61], v15 offset:4096
    ds_read_b64_tr_b16 v[62:63], v15 offset:5120
    v_mfma_f32_32x32x16_bf16 v[96:111], v[20:23], v[32:35], v[96:111]
    ds_read_b128 v[40:43], v11 offset:0
    ds_read_b128 v[44:47], v11 offset:4096
    v_mfma_f32_32x32x16_bf16 v[112:127], v[20:23], v[36:39], v[112:127]
    ds_read_b128 v[48:51], v11 offset:8192
    ds_read_b128 v[52:55], v11 offset:12288
    v_mfma_f32_32x32x16_bf16 v[128:143], v[24:27], v[32:35], v[128:143]
    v_mfma_f32_32x32x16_bf16 v[144:159], v[24:27], v[36:39], v[144:159]
    v_mfma_f32_32x32x16_bf16 v[160:175], v[28:31], v[32:35], v[160:175]
    v_mfma_f32_32x32x16_bf16 v[176:191], v[28:31], v[36:39], v[176:191]
    s_waitcnt vmcnt(9) lgkmcnt(0)
    s_barrier
    s_cmp_eq_u32 s16, 2
    s_cbranch_scc1 Lhook_5_b
Lhook_5_q1:
    v_mfma_f32_32x32x16_bf16 v[64:79], v[40:43], v[56:59], v[64:79]
    ds_read_b64_tr_b16 v[32:33], v14 offset:16384
    ds_read_b64_tr_b16 v[34:35], v14 offset:17408
    v_mfma_f32_32x32x16_bf16 v[80:95], v[40:43], v[60:63], v[80:95]
    ds_read_b64_tr_b16 v[36:37], v15 offset:16384
    ds_read_b64_tr_b16 v[38:39], v15 offset:17408
    v_mfma_f32_32x32x16_bf16 v[96:111], v[44:47], v[56:59], v[96:111]
    ds_read_b128 v[16:19], v12 offset:0
    ds_read_b128 v[20:23], v12 offset:4096
    v_mfma_f32_32x32x16_bf16 v[112:127], v[44:47], v[60:63], v[112:127]
    ds_read_b128 v[24:27], v12 offset:8192
    ds_read_b128 v[28:31], v12 offset:12288
    v_mfma_f32_32x32x16_bf16 v[128:143], v[48:51], v[56:59], v[128:143]
    s_add_u32 m0, s23, 0
    s_nop 0
    buffer_load_dwordx4 v6, s[8:11], s19 offen lds
    v_mfma_f32_32x32x16_bf16 v[144:159], v[48:51], v[60:63], v[144:159]
    s_add_u32 m0, s23, 1024
    s_nop 0
    buffer_load_dwordx4 v7, s[8:11], s19 offen lds
    s_add_u32 s19, s19, s20
    s_add_u32 s23, s23, 0x4000
    s_cmp_ge_u32 s23, 0x28000
    s_cbranch_scc0 1f
    s_sub_u32 s23, s23, 0x10000
    1:
    v_mfma_f32_32x32x16_bf16 v[160:175], v[52:55], v[56:59], v[160:175]
    s_add_u32 m0, s22, 2048
    s_nop 0
    buffer_load_dwordx4 v4, s[4:7], s18 offen sc1 lds
    v_mfma_f32_32x32x16_bf16 v[176:191], v[52:55], v[60:63], v[176:191]
    s_add_u32 m0, s22, 3072
    s_nop 0
    buffer_load_dwordx4 v5, s[4:7], s18 offen sc1 lds
    s_add_u32 s18, s18, 128
    s_add_u32 s22, s22, 0x8000
    s_cmp_ge_u32 s22, 0x18000
    s_cbranch_scc0 1f
    s_sub_u32 s22, s22, 0x18000
    1:
    s_waitcnt lgkmcnt(0)
    v_mfma_f32_32x32x16_bf16 v[64:79], v[16:19], v[32:35], v[64:79]
    ds_read_b64_tr_b16 v[56:57], v14 offset:20480
    ds_read_b64_tr_b16 v[58:59], v14 offset:21504
    v_mfma_f32_32x32x16_bf16 v[80:95], v[16:19], v[36:39], v[80:95]
    ds_read_b64_tr_b16 v[60:61], v15 offset:20480
    ds_read_b64_tr_b16 v[62:63], v15 offset:21504
    v_mfma_f32_32x32x16_bf16 v[96:111], v[20:23], v[32:35], v[96:111]
    ds_read_b128 v[40:43], v13 offset:0
    ds_read_b128 v[44:47], v13 offset:4096
    v_mfma_f32_32x32x16_bf16 v[112:127], v[20:23], v[36:39], v[112:127]
    ds_read_b128 v[48:51], v13 offset:8192
    ds_read_b128 v[52:55], v13 offset:12288
    v_mfma_f32_32x32x16_bf16 v[128:143], v[24:27], v[32:35], v[128:143]
    s_add_u32 s27, s27, 1
    s_cmp_eq_u32 s27, 3
    s_cselect_b32 s27, 0, s27
    s_cselect_b32 s26, s70, s71
    v_mfma_f32_32x32x16_bf16 v[144:159], v[24:27], v[36:39], v[144:159]
    v_mfma_f32_32x32x16_bf16 v[160:175], v[28:31], v[32:35], v[160:175]
    v_mfma_f32_32x32x16_bf16 v[176:191], v[28:31], v[36:39], v[176:191]
    s_waitcnt vmcnt(9) lgkmcnt(0)
    s_barrier
    s_branch Lhook_5
Lhook_5_r1:
    v_add_u32 v10, s26, v10
    v_add_u32 v11, s26, v11
    v_add_u32 v12, s26, v12
    v_add_u32 v13, s26, v13
    v_xor_b32 v14, 0x38000, v14
    v_xor_b32 v15, 0x38000, v15
    v_mfma_f32_32x32x16_bf16 v[64:79], v[40:43], v[56:59], v[64:79]
    ds_read_b64_tr_b16 v[32:33], v14 offset:0
    ds_read_b64_tr_b16 v[34:35], v14 offset:1024
    v_mfma_f32_32x32x16_bf16 v[80:95], v[40:43], v[60:63], v[80:95]
    ds_read_b64_tr_b16 v[36:37], v15 offset:0
    ds_read_b64_tr_b16 v[38:39], v15 offset:1024
    v_mfma_f32_32x32x16_bf16 v[96:111], v[44:47], v[56:59], v[96:111]
    ds_read_b128 v[16:19], v10 offset:0
    ds_read_b128 v[20:23], v10 offset:4096
    v_mfma_f32_32x32x16_bf16 v[112:127], v[44:47], v[60:63], v[112:127]
    ds_read_b128 v[24:27], v10 offset:8192
    ds_read_b128 v[28:31], v10 offset:12288
    v_mfma_f32_32x32x16_bf16 v[128:143], v[48:51], v[56:59], v[128:143]
    s_add_u32 m0, s23, 0
    s_nop 0
    buffer_load_dwordx4 v6, s[8:11], s19 offen lds
    v_mfma_f32_32x32x16_bf16 v[144:159], v[48:51], v[60:63], v[144:159]
    s_add_u32 m0, s23, 1024
    s_nop 0
    buffer_load_dwordx4 v7, s[8:11], s19 offen lds
    s_add_u32 s19, s19, s20
    s_add_u32 s23, s23, 0x4000
    s_cmp_ge_u32 s23, 0x28000
    s_cbranch_scc0 1f
    s_sub_u32 s23, s23, 0x10000
    1:
    v_mfma_f32_32x32x16_bf16 v[160:175], v[52:55], v[56:59], v[160:175]
    s_add_u32 m0, s22, 0
    s_nop 0
    buffer_load_dwordx4 v2, s[4:7], s18 offen sc1 lds
    v_mfma_f32_32x32x16_bf16 v[176:191], v[52:55], v[60:63], v[176:191]
    s_add_u32 m0, s22, 1024
    s_nop 0
    buffer_load_dwordx4 v3, s[4:7], s18 offen sc1 lds
    buffer_load_dwordx4 v[196:199], v195, s[64:67], s68 offen
    s_add_u32 s68, s68, s69
    s_sub_u32 s16, s16, 1
    s_cmp_lg_u32 s16, 0
    s_cbranch_scc1 Lk_7
    s_nop 7
    s_nop 7
    s_lshl_b32 s32, s38, 13
    s_mov_b32 s34, s32
    s_bfe_u32 s39, s21, 0x10001
    s_lshl_b32 s33, s39, 3
    s_add_u32 s35, s33, 4
    s_lshl_b32 s39, s36, 1
    s_add_u32 s39, s39, s38
    s_lshl_b32 s39, s39, 19
    s_add_u32 s31, s39, 37748736
    s_lshl_b32 s39, s33, 10
    s_add_u32 s31, s31, s39
    s_lshl_b32 s39, s37, 8
    s_add_u32 s39, s39, s28
    s_lshl_b32 s39, s39, 8
    s_add_u32 s31, s31, s39
    s_add_u32 s39, s31, 4096
    v_cvt_pk_bf16_f32 v224, v64, v65
    v_cvt_pk_bf16_f32 v225, v66, v67
    v_cvt_pk_bf16_f32 v226, v68, v69
    v_cvt_pk_bf16_f32 v227, v70, v71
    buffer_store_dwordx4 v[224:227], v220, s[12:15], s31 offen offset:0 sc1
    v_mov_b32 v64, 0
    v_mov_b32 v65, 0
    v_mov_b32 v66, 0
    v_mov_b32 v67, 0
    v_mov_b32 v68, 0
    v_mov_b32 v69, 0
    v_mov_b32 v70, 0
    v_mov_b32 v71, 0
    v_cvt_pk_bf16_f32 v228, v72, v73
    v_cvt_pk_bf16_f32 v229, v74, v75
    v_cvt_pk_bf16_f32 v230, v76, v77
    v_cvt_pk_bf16_f32 v231, v78, v79
    buffer_store_dwordx4 v[228:231], v220, s[12:15], s31 offen offset:1024 sc1
    v_mov_b32 v72, 0
    v_mov_b32 v73, 0
    v_mov_b32 v74, 0
    v_mov_b32 v75, 0
    v_mov_b32 v76, 0
    v_mov_b32 v77, 0
    v_mov_b32 v78, 0
    v_mov_b32 v79, 0
    v_cvt_pk_bf16_f32 v232, v80, v81
    v_cvt_pk_bf16_f32 v233, v82, v83
    v_cvt_pk_bf16_f32 v234, v84, v85
    v_cvt_pk_bf16_f32 v235, v86, v87
    buffer_store_dwordx4 v[232:235], v220, s[12:15], s39 offen offset:0 sc1
    v_mov_b32 v80, 0
    v_mov_b32 v81, 0
    v_mov_b32 v82, 0
    v_mov_b32 v83, 0
    v_mov_b32 v84, 0
    v_mov_b32 v85, 0
    v_mov_b32 v86, 0
    v_mov_b32 v87, 0
    v_cvt_pk_bf16_f32 v236, v88, v89
    v_cvt_pk_bf16_f32 v237, v90, v91
    v_cvt_pk_bf16_f32 v238, v92, v93
    v_cvt_pk_bf16_f32 v239, v94, v95
    buffer_store_dwordx4 v[236:239], v220, s[12:15], s39 offen offset:1024 sc1
    v_mov_b32 v88, 0
    v_mov_b32 v89, 0
    v_mov_b32 v90, 0
    v_mov_b32 v91, 0
    v_mov_b32 v92, 0
    v_mov_b32 v93, 0
    v_mov_b32 v94, 0
    v_mov_b32 v95, 0
    v_cvt_pk_bf16_f32 v224, v96, v97
    v_cvt_pk_bf16_f32 v225, v98, v99
    v_cvt_pk_bf16_f32 v226, v100, v101
    v_cvt_pk_bf16_f32 v227, v102, v103
    buffer_store_dwordx4 v[224:227], v220, s[12:15], s31 offen offset:2048 sc1
    v_mov_b32 v96, 0
    v_mov_b32 v97, 0
    v_mov_b32 v98, 0
    v_mov_b32 v99, 0
    v_mov_b32 v100, 0
    v_mov_b32 v101, 0
    v_mov_b32 v102, 0
    v_mov_b32 v103, 0
    v_cvt_pk_bf16_f32 v228, v104, v105
    v_cvt_pk_bf16_f32 v229, v106, v107
    v_cvt_pk_bf16_f32 v230, v108, v109
    v_cvt_pk_bf16_f32 v231, v110, v111
    buffer_store_dwordx4 v[228:231], v220, s[12:15], s31 offen offset:3072 sc1
    v_mov_b32 v104, 0
    v_mov_b32 v105, 0
    v_mov_b32 v106, 0
    v_mov_b32 v107, 0
    v_mov_b32 v108, 0
    v_mov_b32 v109, 0
    v_mov_b32 v110, 0
    v_mov_b32 v111, 0
    v_cvt_pk_bf16_f32 v232, v112, v113
    v_cvt_pk_bf16_f32 v233, v114, v115
    v_cvt_pk_bf16_f32 v234, v116, v117
    v_cvt_pk_bf16_f32 v235, v118, v119
    buffer_store_dwordx4 v[232:235], v220, s[12:15], s39 offen offset:2048 sc1
    v_mov_b32 v112, 0
    v_mov_b32 v113, 0
    v_mov_b32 v114, 0
    v_mov_b32 v115, 0
    v_mov_b32 v116, 0
    v_mov_b32 v117, 0
    v_mov_b32 v118, 0
    v_mov_b32 v119, 0
    v_cvt_pk_bf16_f32 v236, v120, v121
    v_cvt_pk_bf16_f32 v237, v122, v123
    v_cvt_pk_bf16_f32 v238, v124, v125
    v_cvt_pk_bf16_f32 v239, v126, v127
    buffer_store_dwordx4 v[236:239], v220, s[12:15], s39 offen offset:3072 sc1
    v_mov_b32 v120, 0
    v_mov_b32 v121, 0
    v_mov_b32 v122, 0
    v_mov_b32 v123, 0
    v_mov_b32 v124, 0
    v_mov_b32 v125, 0
    v_mov_b32 v126, 0
    v_mov_b32 v127, 0
    s_add_u32 s31, s31, 16384
    s_add_u32 s39, s39, 16384
    s_add_u32 s64, s31, 0
    s_nop 0
    v_cvt_pk_bf16_f32 v224, v128, v129
    v_cvt_pk_bf16_f32 v225, v130, v131
    v_cvt_pk_bf16_f32 v226, v132, v133
    v_cvt_pk_bf16_f32 v227, v134, v135
    v_cvt_pk_bf16_f32 v228, v136, v137
    v_cvt_pk_bf16_f32 v229, v138, v139
    v_cvt_pk_bf16_f32 v230, v140, v141
    v_cvt_pk_bf16_f32 v231, v142, v143
    v_mov_b32 v128, 0
    v_mov_b32 v129, 0
    v_mov_b32 v130, 0
    v_mov_b32 v131, 0
    v_mov_b32 v132, 0
    v_mov_b32 v133, 0
    v_mov_b32 v134, 0
    v_mov_b32 v135, 0
    v_mov_b32 v136, 0
    v_mov_b32 v137, 0
    v_mov_b32 v138, 0
    v_mov_b32 v139, 0
    v_mov_b32 v140, 0
    v_mov_b32 v141, 0
    v_mov_b32 v142, 0
    v_mov_b32 v143, 0
    s_add_u32 s65, s39, 0
    s_nop 0
    v_cvt_pk_bf16_f32 v232, v144, v145
    v_cvt_pk_bf16_f32 v233, v146, v147
    v_cvt_pk_bf16_f32 v234, v148, v149
    v_cvt_pk_bf16_f32 v235, v150, v151
    v_cvt_pk_bf16_f32 v236, v152, v153
    v_cvt_pk_bf16_f32 v237, v154, v155
    v_cvt_pk_bf16_f32 v238, v156, v157
    v_cvt_pk_bf16_f32 v239, v158, v159
    v_mov_b32 v144, 0
    v_mov_b32 v145, 0
    v_mov_b32 v146, 0
    v_mov_b32 v147, 0
    v_mov_b32 v148, 0
    v_mov_b32 v149, 0
    v_mov_b32 v150, 0
    v_mov_b32 v151, 0
    v_mov_b32 v152, 0
    v_mov_b32 v153, 0
    v_mov_b32 v154, 0
    v_mov_b32 v155, 0
    v_mov_b32 v156, 0
    v_mov_b32 v157, 0
    v_mov_b32 v158, 0
    v_mov_b32 v159, 0
    s_add_u32 s66, s31, 2048
    s_nop 0
    v_cvt_pk_bf16_f32 v240, v160, v161
    v_cvt_pk_bf16_f32 v241, v162, v163
    v_cvt_pk_bf16_f32 v242, v164, v165
    v_cvt_pk_bf16_f32 v243, v166, v167
    v_cvt_pk_bf16_f32 v244, v168, v169
    v_cvt_pk_bf16_f32 v245, v170, v171
    v_cvt_pk_bf16_f32 v246, v172, v173
    v_cvt_pk_bf16_f32 v247, v174, v175
    v_mov_b32 v160, 0
    v_mov_b32 v161, 0
    v_mov_b32 v162, 0
    v_mov_b32 v163, 0
    v_mov_b32 v164, 0
    v_mov_b32 v165, 0
    v_mov_b32 v166, 0
    v_mov_b32 v167, 0
    v_mov_b32 v168, 0
    v_mov_b32 v169, 0
    v_mov_b32 v170, 0
    v_mov_b32 v171, 0
    v_mov_b32 v172, 0
    v_mov_b32 v173, 0
    v_mov_b32 v174, 0
    v_mov_b32 v175, 0
    s_add_u32 s67, s39, 2048
    s_nop 0
    v_cvt_pk_bf16_f32 v248, v176, v177
    v_cvt_pk_bf16_f32 v249, v178, v179
    v_cvt_pk_bf16_f32 v250, v180, v181
    v_cvt_pk_bf16_f32 v251, v182, v183
    v_cvt_pk_bf16_f32 v252, v184, v185
    v_cvt_pk_bf16_f32 v253, v186, v187
    v_cvt_pk_bf16_f32 v254, v188, v189
    v_cvt_pk_bf16_f32 v255, v190, v191
    v_mov_b32 v176, 0
    v_mov_b32 v177, 0
    v_mov_b32 v178, 0
    v_mov_b32 v179, 0
    v_mov_b32 v180, 0
    v_mov_b32 v181, 0
    v_mov_b32 v182, 0
    v_mov_b32 v183, 0
    v_mov_b32 v184, 0
    v_mov_b32 v185, 0
    v_mov_b32 v186, 0
    v_mov_b32 v187, 0
    v_mov_b32 v188, 0
    v_mov_b32 v189, 0
    v_mov_b32 v190, 0
    v_mov_b32 v191, 0
Lt2_4:
    s_and_b32 s39, s2, 7
    s_bfe_u32 s31, s2, 0x10004
    s_lshl_b32 s31, s31, 3
    s_add_u32 s39, s39, s31
    v_bfe_u32 v206, v1, 3, 1
    v_lshlrev_b32 v206, 4, v206
    v_add_u32 v206, s39, v206
    v_and_b32 v207, 7, v1
    v_lshrrev_b32 v204, 3, v206
    v_lshlrev_b32 v204, 6, v204
    v_and_b32 v206, 7, v206
    v_add_u32 v204, v204, v206
    v_lshl_add_u32 v204, v207, 3, v204
    v_lshlrev_b32 v204, 8, v204
    v_add_u32 v204, 117768192, v204
    s_mov_b32 s68, 0
    s_cmp_ge_u32 s61, 30
    s_cbranch_scc1 Lpn
    s_mov_b32 s16, 10
    s_nop 0
    s_nop 1
Lk_8:
    s_waitcnt lgkmcnt(0)
    v_mfma_f32_32x32x16_bf16 v[64:79], v[32:35], v[16:19], v[64:79]
    ds_read_b64_tr_b16 v[56:57], v14 offset:4096
    ds_read_b64_tr_b16 v[58:59], v14 offset:5120
    v_mfma_f32_32x32x16_bf16 v[80:95], v[36:39], v[16:19], v[80:95]
    ds_read_b64_tr_b16 v[60:61], v15 offset:4096
    ds_read_b64_tr_b16 v[62:63], v15 offset:5120
    v_mfma_f32_32x32x16_bf16 v[96:111], v[32:35], v[20:23], v[96:111]
    ds_read_b128 v[40:43], v11 offset:0
    ds_read_b128 v[44:47], v11 offset:4096
    v_mfma_f32_32x32x16_bf16 v[112:127], v[36:39], v[20:23], v[112:127]
    ds_read_b128 v[48:51], v11 offset:8192
    ds_read_b128 v[52:55], v11 offset:12288
    v_mfma_f32_32x32x16_bf16 v[128:143], v[32:35], v[24:27], v[128:143]
    v_mfma_f32_32x32x16_bf16 v[144:159], v[36:39], v[24:27], v[144:159]
    v_mfma_f32_32x32x16_bf16 v[160:175], v[32:35], v[28:31], v[160:175]
    v_mfma_f32_32x32x16_bf16 v[176:191], v[36:39], v[28:31], v[176:191]
    s_waitcnt vmcnt(8) lgkmcnt(0)
    s_barrier
    s_cmp_le_u32 s16, 2
    s_cselect_b32 s10, 0, s10
    v_mfma_f32_32x32x16_bf16 v[64:79], v[56:59], v[40:43], v[64:79]
    ds_read_b64_tr_b16 v[32:33], v14 offset:16384
    ds_read_b64_tr_b16 v[34:35], v14 offset:17408
    v_mfma_f32_32x32x16_bf16 v[80:95], v[60:63], v[40:43], v[80:95]
    ds_read_b64_tr_b16 v[36:37], v15 offset:16384
    ds_read_b64_tr_b16 v[38:39], v15 offset:17408
    v_mfma_f32_32x32x16_bf16 v[96:111], v[56:59], v[44:47], v[96:111]
    ds_read_b128 v[16:19], v12 offset:0
    ds_read_b128 v[20:23], v12 offset:4096
    v_mfma_f32_32x32x16_bf16 v[112:127], v[60:63], v[44:47], v[112:127]
    ds_read_b128 v[24:27], v12 offset:8192
    ds_read_b128 v[28:31], v12 offset:12288
    v_mfma_f32_32x32x16_bf16 v[128:143], v[56:59], v[48:51], v[128:143]
    s_add_u32 m0, s23, 0
    s_nop 0
    buffer_load_dwordx4 v6, s[8:11], s19 offen lds
    v_mfma_f32_32x32x16_bf16 v[144:159], v[60:63], v[48:51], v[144:159]
    s_add_u32 m0, s23, 1024
    s_nop 0
    buffer_load_dwordx4 v7, s[8:11], s19 offen lds
    s_add_u32 s19, s19, s20
    s_add_u32 s23, s23, 0x4000
    s_cmp_ge_u32 s23, 0x28000
    s_cbranch_scc0 1f
    s_sub_u32 s23, s23, 0x10000
    1:
    v_mfma_f32_32x32x16_bf16 v[160:175], v[56:59], v[52:55], v[160:175]
    s_add_u32 m0, s22, 2048
    s_nop 0
    buffer_load_dwordx4 v4, s[4:7], s18 offen sc1 lds
    v_mfma_f32_32x32x16_bf16 v[176:191], v[60:63], v[52:55], v[176:191]
    s_add_u32 m0, s22, 3072
    s_nop 0
    buffer_load_dwordx4 v5, s[4:7], s18 offen sc1 lds
    s_add_u32 s18, s18, 128
    s_add_u32 s22, s22, 0x8000
    s_cmp_ge_u32 s22, 0x18000
    s_cbranch_scc0 1f
    s_sub_u32 s22, s22, 0x18000
    1:
    s_waitcnt lgkmcnt(0)
    v_mfma_f32_32x32x16_bf16 v[64:79], v[32:35], v[16:19], v[64:79]
    ds_read_b64_tr_b16 v[56:57], v14 offset:20480
    ds_read_b64_tr_b16 v[58:59], v14 offset:21504
    v_mfma_f32_32x32x16_bf16 v[80:95], v[36:39], v[16:19], v[80:95]
    ds_read_b64_tr_b16 v[60:61], v15 offset:20480
    ds_read_b64_tr_b16 v[62:63], v15 offset:21504
    v_mfma_f32_32x32x16_bf16 v[96:111], v[32:35], v[20:23], v[96:111]
    ds_read_b128 v[40:43], v13 offset:0
    ds_read_b128 v[44:47], v13 offset:4096
    v_mfma_f32_32x32x16_bf16 v[112:127], v[36:39], v[20:23], v[112:127]
    ds_read_b128 v[48:51], v13 offset:8192
    ds_read_b128 v[52:55], v13 offset:12288
    v_mfma_f32_32x32x16_bf16 v[128:143], v[32:35], v[24:27], v[128:143]
    s_add_u32 s27, s27, 1
    s_cmp_eq_u32 s27, 3
    s_cselect_b32 s27, 0, s27
    s_cselect_b32 s26, s70, s71
    v_mfma_f32_32x32x16_bf16 v[144:159], v[36:39], v[24:27], v[144:159]
    v_mfma_f32_32x32x16_bf16 v[160:175], v[32:35], v[28:31], v[160:175]
    v_mfma_f32_32x32x16_bf16 v[176:191], v[36:39], v[28:31], v[176:191]
    s_waitcnt vmcnt(8) lgkmcnt(0)
    s_barrier
    s_cmp_le_u32 s16, 3
    s_cselect_b32 s6, 0, s6
    s_cmp_ge_u32 s16, 7
    s_cbranch_scc1 Ldef
    Ldef_r:
    s_cmp_eq_u32 s16, 5
    s_cbranch_scc0 2f
    s_cmp_eq_u32 s21, 0
    s_cbranch_scc0 1f
    s_lshl_b32 s39, s2, 8
    s_add_u32 s39, s39, 117768192
    v_mov_b32 v202, 0
    v_mov_b32 v203, 1
    s_mov_b64 exec, 1
    buffer_store_dword v203, v202, s[12:15], s39 offen sc1
    s_mov_b64 exec, -1
    1:
    2:
    s_cmp_eq_u32 s16, 2
    s_cbranch_scc0 3f
    buffer_load_dword v205, v204, s[12:15], 0 offen sc1
    3:
    v_add_u32 v10, s26, v10
    v_add_u32 v11, s26, v11
    v_add_u32 v12, s26, v12
    v_add_u32 v13, s26, v13
    v_xor_b32 v14, 0x38000, v14
    v_xor_b32 v15, 0x38000, v15
    v_mfma_f32_32x32x16_bf16 v[64:79], v[56:59], v[40:43], v[64:79]
    ds_read_b64_tr_b16 v[32:33], v14 offset:0
    ds_read_b64_tr_b16 v[34:35], v14 offset:1024
    v_mfma_f32_32x32x16_bf16 v[80:95], v[60:63], v[40:43], v[80:95]
    ds_read_b64_tr_b16 v[36:37], v15 offset:0
    ds_read_b64_tr_b16 v[38:39], v15 offset:1024
    v_mfma_f32_32x32x16_bf16 v[96:111], v[56:59], v[44:47], v[96:111]
    ds_read_b128 v[16:19], v10 offset:0
    ds_read_b128 v[20:23], v10 offset:4096
    v_mfma_f32_32x32x16_bf16 v[112:127], v[60:63], v[44:47], v[112:127]
    ds_read_b128 v[24:27], v10 offset:8192
    ds_read_b128 v[28:31], v10 offset:12288
    v_mfma_f32_32x32x16_bf16 v[128:143], v[56:59], v[48:51], v[128:143]
    s_add_u32 m0, s23, 0
    s_nop 0
    buffer_load_dwordx4 v6, s[8:11], s19 offen lds
    v_mfma_f32_32x32x16_bf16 v[144:159], v[60:63], v[48:51], v[144:159]
    s_add_u32 m0, s23, 1024
    s_nop 0
    buffer_load_dwordx4 v7, s[8:11], s19 offen lds
    s_add_u32 s19, s19, s20
    s_add_u32 s23, s23, 0x4000
    s_cmp_ge_u32 s23, 0x28000
    s_cbranch_scc0 1f
    s_sub_u32 s23, s23, 0x10000
    1:
    v_mfma_f32_32x32x16_bf16 v[160:175], v[56:59], v[52:55], v[160:175]
    s_add_u32 m0, s22, 0
    s_nop 0
    buffer_load_dwordx4 v2, s[4:7], s18 offen sc1 lds
    v_mfma_f32_32x32x16_bf16 v[176:191], v[60:63], v[52:55], v[176:191]
    s_add_u32 m0, s22, 1024
    s_nop 0
    buffer_load_dwordx4 v3, s[4:7], s18 offen sc1 lds
    s_sub_u32 s16, s16, 1
    s_cmp_lg_u32 s16, 0
    s_cbranch_scc1 Lk_8
    s_nop 7
    s_nop 7
    s_cmp_ge_u32 s61, 16
    s_cbranch_scc1 Lge_9
    s_mov_b32 s36, s61
    s_mov_b32 s31, 4194304
    s_lshl_b32 s32, s38, 13
    s_mov_b32 s34, s32
    s_bfe_u32 s39, s21, 0x10001
    s_lshl_b32 s33, s39, 3
    s_add_u32 s35, s33, 4
    s_cmp_lt_u32 s37, 4
    s_cbranch_scc0 Lqnow
    s_lshl_b32 s39, s36, 1
    s_add_u32 s39, s39, s38
    s_lshl_b32 s39, s39, 19
    s_add_u32 s31, s31, s39
    s_lshl_b32 s39, s37, 8
    s_add_u32 s39, s39, s28
    s_lshl_b32 s39, s39, 8
    s_add_u32 s31, s31, s39
    s_lshl_b32 s39, s33, 9
    s_add_u32 s31, s31, s39
    v_cvt_pk_bf16_f32 v224, v64, v65
    v_cvt_pk_bf16_f32 v225, v66, v67
    v_cvt_pk_bf16_f32 v226, v68, v69
    v_cvt_pk_bf16_f32 v227, v70, v71
    buffer_store_dwordx4 v[224:227], v220, s[12:15], s31 offen offset:0 sc1
    v_cvt_pk_bf16_f32 v228, v72, v73
    v_cvt_pk_bf16_f32 v229, v74, v75
    v_cvt_pk_bf16_f32 v230, v76, v77
    v_cvt_pk_bf16_f32 v231, v78, v79
    buffer_store_dwordx4 v[228:231], v220, s[12:15], s31 offen offset:1024 sc1
    v_cvt_pk_bf16_f32 v232, v80, v81
    v_cvt_pk_bf16_f32 v233, v82, v83
    v_cvt_pk_bf16_f32 v234, v84, v85
    v_cvt_pk_bf16_f32 v235, v86, v87
    buffer_store_dwordx4 v[232:235], v220, s[12:15], s31 offen offset:2048 sc1
    v_cvt_pk_bf16_f32 v236, v88, v89
    v_cvt_pk_bf16_f32 v237, v90, v91
    v_cvt_pk_bf16_f32 v238, v92, v93
    v_cvt_pk_bf16_f32 v239, v94, v95
    buffer_store_dwordx4 v[236:239], v220, s[12:15], s31 offen offset:3072 sc1
    s_add_u32 s31, s31, 8192
    v_cvt_pk_bf16_f32 v224, v96, v97
    v_cvt_pk_bf16_f32 v225, v98, v99
    v_cvt_pk_bf16_f32 v226, v100, v101
    v_cvt_pk_bf16_f32 v227, v102, v103
    buffer_store_dwordx4 v[224:227], v220, s[12:15], s31 offen offset:0 sc1
    v_cvt_pk_bf16_f32 v228, v104, v105
    v_cvt_pk_bf16_f32 v229, v106, v107
    v_cvt_pk_bf16_f32 v230, v108, v109
    v_cvt_pk_bf16_f32 v231, v110, v111
    buffer_store_dwordx4 v[228:231], v220, s[12:15], s31 offen offset:1024 sc1
    v_cvt_pk_bf16_f32 v232, v112, v113
    v_cvt_pk_bf16_f32 v233, v114, v115
    v_cvt_pk_bf16_f32 v234, v116, v117
    v_cvt_pk_bf16_f32 v235, v118, v119
    buffer_store_dwordx4 v[232:235], v220, s[12:15], s31 offen offset:2048 sc1
    v_cvt_pk_bf16_f32 v236, v120, v121
    v_cvt_pk_bf16_f32 v237, v122, v123
    v_cvt_pk_bf16_f32 v238, v124, v125
    v_cvt_pk_bf16_f32 v239, v126, v127
    buffer_store_dwordx4 v[236:239], v220, s[12:15], s31 offen offset:3072 sc1
    s_add_u32 s31, s31, 8192
    s_add_u32 s64, s31, 0
    s_nop 0
    v_cvt_pk_bf16_f32 v224, v128, v129
    v_cvt_pk_bf16_f32 v225, v130, v131
    v_cvt_pk_bf16_f32 v226, v132, v133
    v_cvt_pk_bf16_f32 v227, v134, v135
    v_cvt_pk_bf16_f32 v228, v136, v137
    v_cvt_pk_bf16_f32 v229, v138, v139
    v_cvt_pk_bf16_f32 v230, v140, v141
    v_cvt_pk_bf16_f32 v231, v142, v143
    s_add_u32 s65, s31, 2048
    s_nop 0
    v_cvt_pk_bf16_f32 v232, v144, v145
    v_cvt_pk_bf16_f32 v233, v146, v147
    v_cvt_pk_bf16_f32 v234, v148, v149
    v_cvt_pk_bf16_f32 v235, v150, v151
    v_cvt_pk_bf16_f32 v236, v152, v153
    v_cvt_pk_bf16_f32 v237, v154, v155
    v_cvt_pk_bf16_f32 v238, v156, v157
    v_cvt_pk_bf16_f32 v239, v158, v159
    s_add_u32 s31, s31, 8192
    s_add_u32 s66, s31, 0
    s_nop 0
    v_cvt_pk_bf16_f32 v240, v160, v161
    v_cvt_pk_bf16_f32 v241, v162, v163
    v_cvt_pk_bf16_f32 v242, v164, v165
    v_cvt_pk_bf16_f32 v243, v166, v167
    v_cvt_pk_bf16_f32 v244, v168, v169
    v_cvt_pk_bf16_f32 v245, v170, v171
    v_cvt_pk_bf16_f32 v246, v172, v173
    v_cvt_pk_bf16_f32 v247, v174, v175
    s_add_u32 s67, s31, 2048
    s_nop 0
    v_cvt_pk_bf16_f32 v248, v176, v177
    v_cvt_pk_bf16_f32 v249, v178, v179
    v_cvt_pk_bf16_f32 v250, v180, v181
    v_cvt_pk_bf16_f32 v251, v182, v183
    v_cvt_pk_bf16_f32 v252, v184, v185
    v_cvt_pk_bf16_f32 v253, v186, v187
    v_cvt_pk_bf16_f32 v254, v188, v189
    v_cvt_pk_bf16_f32 v255, v190, v191
    s_add_u32 s31, s31, 8192
    s_mov_b32 s68, 1
    s_waitcnt vmcnt(8)
    s_branch Lpj
Lqnow:
    s_lshl_b32 s39, s36, 1
    s_add_u32 s39, s39, s38
    s_lshl_b32 s39, s39, 19
    s_add_u32 s31, s31, s39
    s_lshl_b32 s39, s37, 8
    s_add_u32 s39, s39, s28
    s_lshl_b32 s39, s39, 8
    s_add_u32 s31, s31, s39
    s_lshl_b32 s39, s33, 9
    s_add_u32 s31, s31, s39
    v_cvt_pk_bf16_f32 v224, v64, v65
    v_cvt_pk_bf16_f32 v225, v66, v67
    v_cvt_pk_bf16_f32 v226, v68, v69
    v_cvt_pk_bf16_f32 v227, v70, v71
    buffer_store_dwordx4 v[224:227], v220, s[12:15], s31 offen offset:0 sc1
    v_cvt_pk_bf16_f32 v228, v72, v73
    v_cvt_pk_bf16_f32 v229, v74, v75
    v_cvt_pk_bf16_f32 v230, v76, v77
    v_cvt_pk_bf16_f32 v231, v78, v79
    buffer_store_dwordx4 v[228:231], v220, s[12:15], s31 offen offset:1024 sc1
    v_cvt_pk_bf16_f32 v232, v80, v81
    v_cvt_pk_bf16_f32 v233, v82, v83
    v_cvt_pk_bf16_f32 v234, v84, v85
    v_cvt_pk_bf16_f32 v235, v86, v87
    buffer_store_dwordx4 v[232:235], v220, s[12:15], s31 offen offset:2048 sc1
    v_cvt_pk_bf16_f32 v236, v88, v89
    v_cvt_pk_bf16_f32 v237, v90, v91
    v_cvt_pk_bf16_f32 v238, v92, v93
    v_cvt_pk_bf16_f32 v239, v94, v95
    buffer_store_dwordx4 v[236:239], v220, s[12:15], s31 offen offset:3072 sc1
    s_add_u32 s31, s31, 8192
    v_cvt_pk_bf16_f32 v224, v96, v97
    v_cvt_pk_bf16_f32 v225, v98, v99
    v_cvt_pk_bf16_f32 v226, v100, v101
    v_cvt_pk_bf16_f32 v227, v102, v103
    buffer_store_dwordx4 v[224:227], v220, s[12:15], s31 offen offset:0 sc1
    v_cvt_pk_bf16_f32 v228, v104, v105
    v_cvt_pk_bf16_f32 v229, v106, v107
    v_cvt_pk_bf16_f32 v230, v108, v109
    v_cvt_pk_bf16_f32 v231, v110, v111
    buffer_store_dwordx4 v[228:231], v220, s[12:15], s31 offen offset:1024 sc1
    v_cvt_pk_bf16_f32 v232, v112, v113
    v_cvt_pk_bf16_f32 v233, v114, v115
    v_cvt_pk_bf16_f32 v234, v116, v117
    v_cvt_pk_bf16_f32 v235, v118, v119
    buffer_store_dwordx4 v[232:235], v220, s[12:15], s31 offen offset:2048 sc1
    v_cvt_pk_bf16_f32 v236, v120, v121
    v_cvt_pk_bf16_f32 v237, v122, v123
    v_cvt_pk_bf16_f32 v238, v124, v125
    v_cvt_pk_bf16_f32 v239, v126, v127
    buffer_store_dwordx4 v[236:239], v220, s[12:15], s31 offen offset:3072 sc1
    s_add_u32 s31, s31, 8192
    v_cvt_pk_bf16_f32 v224, v128, v129
    v_cvt_pk_bf16_f32 v225, v130, v131
    v_cvt_pk_bf16_f32 v226, v132, v133
    v_cvt_pk_bf16_f32 v227, v134, v135
    buffer_store_dwordx4 v[224:227], v220, s[12:15], s31 offen offset:0 sc1
    v_cvt_pk_bf16_f32 v228, v136, v137
    v_cvt_pk_bf16_f32 v229, v138, v139
    v_cvt_pk_bf16_f32 v230, v140, v141
    v_cvt_pk_bf16_f32 v231, v142, v143
    buffer_store_dwordx4 v[228:231], v220, s[12:15], s31 offen offset:1024 sc1
    v_cvt_pk_bf16_f32 v232, v144, v145
    v_cvt_pk_bf16_f32 v233, v146, v147
    v_cvt_pk_bf16_f32 v234, v148, v149
    v_cvt_pk_bf16_f32 v235, v150, v151
    buffer_store_dwordx4 v[232:235], v220, s[12:15], s31 offen offset:2048 sc1
    v_cvt_pk_bf16_f32 v236, v152, v153
    v_cvt_pk_bf16_f32 v237, v154, v155
    v_cvt_pk_bf16_f32 v238, v156, v157
    v_cvt_pk_bf16_f32 v239, v158, v159
    buffer_store_dwordx4 v[236:239], v220, s[12:15], s31 offen offset:3072 sc1
    s_add_u32 s31, s31, 8192
    v_cvt_pk_bf16_f32 v224, v160, v161
    v_cvt_pk_bf16_f32 v225, v162, v163
    v_cvt_pk_bf16_f32 v226, v164, v165
    v_cvt_pk_bf16_f32 v227, v166, v167
    buffer_store_dwordx4 v[224:227], v220, s[12:15], s31 offen offset:0 sc1
    v_cvt_pk_bf16_f32 v228, v168, v169
    v_cvt_pk_bf16_f32 v229, v170, v171
    v_cvt_pk_bf16_f32 v230, v172, v173
    v_cvt_pk_bf16_f32 v231, v174, v175
    buffer_store_dwordx4 v[228:231], v220, s[12:15], s31 offen offset:1024 sc1
    v_cvt_pk_bf16_f32 v232, v176, v177
    v_cvt_pk_bf16_f32 v233, v178, v179
    v_cvt_pk_bf16_f32 v234, v180, v181
    v_cvt_pk_bf16_f32 v235, v182, v183
    buffer_store_dwordx4 v[232:235], v220, s[12:15], s31 offen offset:2048 sc1
    v_cvt_pk_bf16_f32 v236, v184, v185
    v_cvt_pk_bf16_f32 v237, v186, v187
    v_cvt_pk_bf16_f32 v238, v188, v189
    v_cvt_pk_bf16_f32 v239, v190, v191
    buffer_store_dwordx4 v[236:239], v220, s[12:15], s31 offen offset:3072 sc1
    s_add_u32 s31, s31, 8192
    s_lshl_b32 s39, s2, 8
    s_lshl_b32 s31, s21, 2
    s_add_u32 s39, s39, s31
    s_add_u32 s39, s39, 117768256
    v_mov_b32 v202, 0
    v_mov_b32 v203, 1
    s_mov_b64 exec, 1
    s_waitcnt vmcnt(0)
    buffer_store_dword v203, v202, s[12:15], s39 offen sc1
    s_mov_b64 exec, -1
    s_branch Lpj
Ldef:
    s_cmp_eq_u32 s16, 10
    s_cbranch_scc0 1f
    buffer_store_dwordx4 v[224:227], v220, s[12:15], s64 offen offset:0 sc1
    buffer_store_dwordx4 v[228:231], v220, s[12:15], s64 offen offset:1024 sc1
    s_branch Ldef_r
    1:
    s_cmp_eq_u32 s16, 9
    s_cbranch_scc0 1f
    buffer_store_dwordx4 v[232:235], v220, s[12:15], s65 offen offset:0 sc1
    buffer_store_dwordx4 v[236:239], v220, s[12:15], s65 offen offset:1024 sc1
    s_branch Ldef_r
    1:
    s_cmp_eq_u32 s16, 8
    s_cbranch_scc0 1f
    buffer_store_dwordx4 v[240:243], v220, s[12:15], s66 offen offset:0 sc1
    buffer_store_dwordx4 v[244:247], v220, s[12:15], s66 offen offset:1024 sc1
    s_branch Ldef_r
    1:
    s_cmp_eq_u32 s16, 7
    s_cbranch_scc0 1f
    buffer_store_dwordx4 v[248:251], v220, s[12:15], s67 offen offset:0 sc1
    buffer_store_dwordx4 v[252:255], v220, s[12:15], s67 offen offset:1024 sc1
    s_branch Ldef_r
    1:
    s_branch Ldef_r
Lpn:
    buffer_store_dwordx4 v[224:227], v220, s[12:15], s64 offen offset:0 sc1
    buffer_store_dwordx4 v[228:231], v220, s[12:15], s64 offen offset:1024 sc1
    buffer_store_dwordx4 v[232:235], v220, s[12:15], s65 offen offset:0 sc1
    buffer_store_dwordx4 v[236:239], v220, s[12:15], s65 offen offset:1024 sc1
    buffer_store_dwordx4 v[240:243], v220, s[12:15], s66 offen offset:0 sc1
    buffer_store_dwordx4 v[244:247], v220, s[12:15], s66 offen offset:1024 sc1
    buffer_store_dwordx4 v[248:251], v220, s[12:15], s67 offen offset:0 sc1
    buffer_store_dwordx4 v[252:255], v220, s[12:15], s67 offen offset:1024 sc1
    s_waitcnt vmcnt(0)
    s_barrier
    s_cmp_eq_u32 s21, 0
    s_cbranch_scc0 1f
    s_lshl_b32 s39, s2, 8
    s_add_u32 s39, s39, 117768192
    v_mov_b32 v202, 0
    v_mov_b32 v203, 1
    s_mov_b64 exec, 1
    buffer_store_dword v203, v202, s[12:15], s39 offen sc1
    s_mov_b64 exec, -1
    1:
    v_mov_b32 v205, 0
Lskip:
    s_waitcnt vmcnt(0)
    s_branch Lpj
Lge_9:
    s_sub_u32 s36, s61, 16
    s_lshl_b32 s39, s36, 3
    s_lshr_b32 s31, s21, 1
    s_lshl_b32 s31, s31, 1
    s_add_u32 s39, s39, s31
    s_cmp_ge_u32 s39, 108
    s_cbranch_scc1 Lskip
    s_lshl_b32 s39, s39, 10
    s_add_u32 s31, s39, 54788096
    s_lshl_b32 s39, s37, 3
    s_lshr_b32 s33, s28, 5
    s_add_u32 s39, s39, s33
    s_mul_i32 s39, s39, 372736
    s_add_u32 s31, s31, s39
    v_max_f32 v64, 0, v64
    v_max_f32 v65, 0, v65
    v_max_f32 v66, 0, v66
    v_max_f32 v67, 0, v67
    v_max_f32 v68, 0, v68
    v_max_f32 v69, 0, v69
    v_max_f32 v70, 0, v70
    v_max_f32 v71, 0, v71
    v_max_f32 v72, 0, v72
    v_max_f32 v73, 0, v73
    v_max_f32 v74, 0, v74
    v_max_f32 v75, 0, v75
    v_max_f32 v76, 0, v76
    v_max_f32 v77, 0, v77
    v_max_f32 v78, 0, v78
    v_max_f32 v79, 0, v79
    v_mul_f32 v64, v64, v80
    v_mul_f32 v65, v65, v81
    v_mul_f32 v66, v66, v82
    v_mul_f32 v67, v67, v83
    v_mul_f32 v68, v68, v84
    v_mul_f32 v69, v69, v85
    v_mul_f32 v70, v70, v86
    v_mul_f32 v71, v71, v87
    v_mul_f32 v72, v72, v88
    v_mul_f32 v73, v73, v89
    v_mul_f32 v74, v74, v90
    v_mul_f32 v75, v75, v91
    v_mul_f32 v76, v76, v92
    v_mul_f32 v77, v77, v93
    v_mul_f32 v78, v78, v94
    v_mul_f32 v79, v79, v95
    s_add_u32 s64, s31, 0
    s_nop 0
    v_cvt_pk_bf16_f32 v224, v64, v65
    v_cvt_pk_bf16_f32 v225, v66, v67
    v_cvt_pk_bf16_f32 v226, v68, v69
    v_cvt_pk_bf16_f32 v227, v70, v71
    v_cvt_pk_bf16_f32 v228, v72, v73
    v_cvt_pk_bf16_f32 v229, v74, v75
    v_cvt_pk_bf16_f32 v230, v76, v77
    v_cvt_pk_bf16_f32 v231, v78, v79
    s_add_u32 s31, s31, 372736
    v_max_f32 v96, 0, v96
    v_max_f32 v97, 0, v97
    v_max_f32 v98, 0, v98
    v_max_f32 v99, 0, v99
    v_max_f32 v100, 0, v100
    v_max_f32 v101, 0, v101
    v_max_f32 v102, 0, v102
    v_max_f32 v103, 0, v103
    v_max_f32 v104, 0, v104
    v_max_f32 v105, 0, v105
    v_max_f32 v106, 0, v106
    v_max_f32 v107, 0, v107
    v_max_f32 v108, 0, v108
    v_max_f32 v109, 0, v109
    v_max_f32 v110, 0, v110
    v_max_f32 v111, 0, v111
    v_mul_f32 v96, v96, v112
    v_mul_f32 v97, v97, v113
    v_mul_f32 v98, v98, v114
    v_mul_f32 v99, v99, v115
    v_mul_f32 v100, v100, v116
    v_mul_f32 v101, v101, v117
    v_mul_f32 v102, v102, v118
    v_mul_f32 v103, v103, v119
    v_mul_f32 v104, v104, v120
    v_mul_f32 v105, v105, v121
    v_mul_f32 v106, v106, v122
    v_mul_f32 v107, v107, v123
    v_mul_f32 v108, v108, v124
    v_mul_f32 v109, v109, v125
    v_mul_f32 v110, v110, v126
    v_mul_f32 v111, v111, v127
    s_add_u32 s65, s31, 0
    s_nop 0
    v_cvt_pk_bf16_f32 v232, v96, v97
    v_cvt_pk_bf16_f32 v233, v98, v99
    v_cvt_pk_bf16_f32 v234, v100, v101
    v_cvt_pk_bf16_f32 v235, v102, v103
    v_cvt_pk_bf16_f32 v236, v104, v105
    v_cvt_pk_bf16_f32 v237, v106, v107
    v_cvt_pk_bf16_f32 v238, v108, v109
    v_cvt_pk_bf16_f32 v239, v110, v111
    s_add_u32 s31, s31, 372736
    v_max_f32 v128, 0, v128
    v_max_f32 v129, 0, v129
    v_max_f32 v130, 0, v130
    v_max_f32 v131, 0, v131
    v_max_f32 v132, 0, v132
    v_max_f32 v133, 0, v133
    v_max_f32 v134, 0, v134
    v_max_f32 v135, 0, v135
    v_max_f32 v136, 0, v136
    v_max_f32 v137, 0, v137
    v_max_f32 v138, 0, v138
    v_max_f32 v139, 0, v139
    v_max_f32 v140, 0, v140
    v_max_f32 v141, 0, v141
    v_max_f32 v142, 0, v142
    v_max_f32 v143, 0, v143
    v_mul_f32 v128, v128, v144
    v_mul_f32 v129, v129, v145
    v_mul_f32 v130, v130, v146
    v_mul_f32 v131, v131, v147
    v_mul_f32 v132, v132, v148
    v_mul_f32 v133, v133, v149
    v_mul_f32 v134, v134, v150
    v_mul_f32 v135, v135, v151
    v_mul_f32 v136, v136, v152
    v_mul_f32 v137, v137, v153
    v_mul_f32 v138, v138, v154
    v_mul_f32 v139, v139, v155
    v_mul_f32 v140, v140, v156
    v_mul_f32 v141, v141, v157
    v_mul_f32 v142, v142, v158
    v_mul_f32 v143, v143, v159
    s_add_u32 s66, s31, 0
    s_nop 0
    v_cvt_pk_bf16_f32 v240, v128, v129
    v_cvt_pk_bf16_f32 v241, v130, v131
    v_cvt_pk_bf16_f32 v242, v132, v133
    v_cvt_pk_bf16_f32 v243, v134, v135
    v_cvt_pk_bf16_f32 v244, v136, v137
    v_cvt_pk_bf16_f32 v245, v138, v139
    v_cvt_pk_bf16_f32 v246, v140, v141
    v_cvt_pk_bf16_f32 v247, v142, v143
    s_add_u32 s31, s31, 372736
    v_max_f32 v160, 0, v160
    v_max_f32 v161, 0, v161
    v_max_f32 v162, 0, v162
    v_max_f32 v163, 0, v163
    v_max_f32 v164, 0, v164
    v_max_f32 v165, 0, v165
    v_max_f32 v166, 0, v166
    v_max_f32 v167, 0, v167
    v_max_f32 v168, 0, v168
    v_max_f32 v169, 0, v169
    v_max_f32 v170, 0, v170
    v_max_f32 v171, 0, v171
    v_max_f32 v172, 0, v172
    v_max_f32 v173, 0, v173
    v_max_f32 v174, 0, v174
    v_max_f32 v175, 0, v175
    v_mul_f32 v160, v160, v176
    v_mul_f32 v161, v161, v177
    v_mul_f32 v162, v162, v178
    v_mul_f32 v163, v163, v179
    v_mul_f32 v164, v164, v180
    v_mul_f32 v165, v165, v181
    v_mul_f32 v166, v166, v182
    v_mul_f32 v167, v167, v183
    v_mul_f32 v168, v168, v184
    v_mul_f32 v169, v169, v185
    v_mul_f32 v170, v170, v186
    v_mul_f32 v171, v171, v187
    v_mul_f32 v172, v172, v188
    v_mul_f32 v173, v173, v189
    v_mul_f32 v174, v174, v190
    v_mul_f32 v175, v175, v191
    s_add_u32 s67, s31, 0
    s_nop 0
    v_cvt_pk_bf16_f32 v248, v160, v161
    v_cvt_pk_bf16_f32 v249, v162, v163
    v_cvt_pk_bf16_f32 v250, v164, v165
    v_cvt_pk_bf16_f32 v251, v166, v167
    v_cvt_pk_bf16_f32 v252, v168, v169
    v_cvt_pk_bf16_f32 v253, v170, v171
    v_cvt_pk_bf16_f32 v254, v172, v173
    v_cvt_pk_bf16_f32 v255, v174, v175
    s_add_u32 s31, s31, 372736
    s_mov_b32 s68, 1
    s_waitcnt vmcnt(0)
    s_branch Lpj
proj_kernel_done:
    s_endpgm
Lhook_5:
    s_cmp_eq_u32 s16, 7
    s_cbranch_scc1 Lh_10
    s_cmp_eq_u32 s16, 5
    s_cbranch_scc1 Lh_11
    s_cmp_eq_u32 s16, 4
    s_cbranch_scc1 Lh_12
    s_cmp_eq_u32 s16, 3
    s_cbranch_scc1 Lh_13
    s_cmp_eq_u32 s16, 1
    s_cbranch_scc1 Lh_14
Lh_15:
    s_cmp_eq_u32 s30, 2
    s_cbranch_scc1 Lhook_5_r1
    s_branch Lhook_5_r0
Lh_10:
    s_cmp_eq_u32 s21, 0
    s_cbranch_scc0 Lh_15
    s_lshr_b32 s39, s2, 5
    s_lshl_b32 s39, s39, 5
    v_mov_b32 v202, 1
    s_mov_b64 s[58:59], exec
    s_mov_b64 exec, 1
    buffer_atomic_add v202, v200, s[40:43], s39 offen sc1
    s_mov_b64 exec, s[58:59]
    s_branch Lh_15
Lh_11:
    s_cmp_eq_u32 s21, 0
    s_cbranch_scc0 Lh_15
    buffer_load_dword v201, v204, s[40:43], 0 offen sc1
    s_branch Lh_15
Lh_12:
    s_cmp_eq_u32 s21, 0
    s_cbranch_scc0 Lh_15
Lpoll_16:
    v_cmp_gt_u32 vcc, 32, v201
    s_cbranch_vccz Lh_15
    s_sleep 4
    buffer_load_dword v201, v204, s[40:43], 0 offen sc1
    s_waitcnt vmcnt(0)
    s_branch Lpoll_16
Lh_13:
    s_mov_b32 s4, s56
    s_and_b32 s5, s57, 0xffff
    s_mov_b32 s6, 2621440
    s_mov_b32 s7, 0x00020000
    s_mov_b32 s24, 1280
    s_mul_i32 s18, s37, 327680
    s_cmp_ge_u32 s61, 30
    s_cselect_b32 s6, 0, s6
    s_lshl_b32 s29, s21, 5
    v_lshrrev_b32 v204, 3, v1
    v_add_u32 v204, s29, v204
    v_lshrrev_b32 v205, 4, v1
    v_and_b32 v206, 7, v1
    v_add_u32 v207, 0, v204
    v_mul_lo_u32 v207, v207, s24
    v_add_u32 v208, 0, v205
    v_xor_b32 v208, v208, v206
    v_lshl_add_u32 v2, v208, 4, v207
    v_add_u32 v207, 8, v204
    v_mul_lo_u32 v207, v207, s24
    v_add_u32 v208, 4, v205
    v_xor_b32 v208, v208, v206
    v_lshl_add_u32 v3, v208, 4, v207
    v_add_u32 v207, 16, v204
    v_mul_lo_u32 v207, v207, s24
    v_add_u32 v208, 0, v205
    v_xor_b32 v208, v208, v206
    v_lshl_add_u32 v4, v208, 4, v207
    v_add_u32 v207, 24, v204
    v_mul_lo_u32 v207, v207, s24
    v_add_u32 v208, 4, v205
    v_xor_b32 v208, v208, v206
    v_lshl_add_u32 v5, v208, 4, v207
    s_branch Lh_15
Lhook_5_b:
    s_cmp_ge_u32 s61, 16
    s_cbranch_scc1 Lhg_17
    s_mov_b32 s8, s44
    s_and_b32 s9, s45, 0xffff
    s_mov_b32 s10, 5242880
    s_mov_b32 s11, 0x00020000
    s_lshl_b32 s19, s61, 1
    s_add_u32 s19, s19, s38
    s_lshl_b32 s19, s19, 8
    s_branch Lhj_18
Lhg_17:
    s_cmp_eq_u32 s38, 0
    s_cselect_b32 s62, s52, s54
    s_cselect_b32 s63, s53, s55
    s_mov_b32 s8, s62
    s_and_b32 s9, s63, 0xffff
    s_mov_b32 s10, 2211840
    s_mov_b32 s11, 0x00020000
    s_mov_b32 s25, 3456
    s_sub_u32 s19, s61, 16
    s_lshl_b32 s19, s19, 8
    s_cmp_ge_u32 s61, 30
    s_cselect_b32 s10, 0, s10
    s_and_b32 s29, s21, 3
    s_lshl_b32 s29, s29, 3
    v_lshrrev_b32 v205, 4, v1
    v_add_u32 v204, s29, v205
    v_lshlrev_b32 v205, 2, v205
    v_and_b32 v206, 15, v1
    v_xor_b32 v206, v206, v205
    v_lshlrev_b32 v206, 4, v206
    v_add_u32 v207, 0, v204
    v_mul_lo_u32 v207, v207, s25
    v_add_u32 v6, v207, v206
    v_add_u32 v207, 4, v204
    v_mul_lo_u32 v207, v207, s25
    v_add_u32 v7, v207, v206
    s_lshl_b32 s20, s25, 5
Lhj_18:
    s_cmp_eq_u32 s30, 2
    s_cbranch_scc1 Lhook_5_q1
    s_branch Lhook_5_q0
Lh_14:
    s_cmp_ge_u32 s61, 16
    s_cbranch_scc0 Lh_15
    s_mov_b32 s32, 0x8000
    s_mov_b32 s34, 0xa000
    s_lshr_b32 s39, s21, 1
    s_lshl_b32 s33, s39, 2
    s_mov_b32 s35, s33
    v_lshrrev_b32 v204, 5, v1
    v_and_b32 v205, 31, v1
    v_add_u32 v205, s28, v205
    v_lshlrev_b32 v205, 7, v205
    v_bfe_u32 v206, v1, 1, 3
    v_bfe_u32 v205, v1, 2, 2
    v_lshlrev_b32 v206, 3, v204
    v_add_u32 v206, v206, v205
    v_lshlrev_b32 v206, 8, v206
    v_and_b32 v207, 1, v1
    v_lshl_add_u32 v206, v207, 3, v206
    v_add_u32 v206, 0x18000, v206
    v_bfe_u32 v207, v1, 4, 1
    v_lshlrev_b32 v207, 1, v207
    v_bfe_u32 v208, v1, 1, 1
    v_add_u32 v207, v207, v208
    v_lshlrev_b32 v205, 2, v205
    v_add_u32 v208, s33, v207
    v_xor_b32 v208, v208, v205
    v_lshl_add_u32 v208, v208, 4, v206
    v_add_u32 v14, s32, v208
    v_add_u32 v208, s35, v207
    v_xor_b32 v208, v208, v205
    v_lshl_add_u32 v208, v208, 4, v206
    v_add_u32 v15, s34, v208
    s_branch Lh_15
Lpj:
    s_branch Lchk_21
Lpoll_19:
    buffer_load_dword v205, v204, s[12:15], 0 offen sc1
    s_waitcnt vmcnt(0)
Lchk_21:
    v_cmp_eq_u32 vcc, 0, v205
    s_cbranch_vccz Lrdy_20
    s_sleep 16
    s_branch Lpoll_19
Lrdy_20:
    s_cmp_ge_u32 s2, 256
    s_cbranch_scc1 attn_kernel_done
    s_load_dwordx2 s[8:9], s[0:1], 96
    s_load_dwordx2 s[44:45], s[0:1], 40
    s_load_dwordx2 s[46:47], s[0:1], 72
    v_and_b32 v1, 63, v0
    v_lshrrev_b32 v2, 6, v0
    s_nop 0
    v_readfirstlane_b32 s21, v2
    s_and_b32 s3, s2, 7
    s_lshl_b32 s3, s3, 1
    s_bfe_u32 s30, s2, 0x10003
    s_add_u32 s34, s3, s30
    s_and_b32 s30, s2, 16
    s_add_u32 s34, s34, s30
    s_lshl_b32 s24, s34, 19
    s_lshr_b32 s35, s2, 5
    s_sub_u32 s17, 15, s35
    s_add_u32 s31, s17, 1
    s_lshr_b32 s20, s21, 2
    s_and_b32 s22, s21, 3
    s_lshl_b32 s23, s20, 16
    s_lshl_b32 s30, s22, 12
    s_add_u32 s23, s23, s30
    s_mov_b32 s28, 0
    v_lshlrev_b32 v5, 4, v1
    s_lshl_b32 s33, s20, 14
    s_add_u32 s30, s30, s33
    v_add_u32 v2, s30, v5
    s_waitcnt lgkmcnt(0)
    s_barrier
    s_mov_b32 s4, s8
    s_and_b32 s5, s9, 0xffff
    s_mov_b32 s6, 268435456
    s_mov_b32 s7, 0x00020000
    s_add_u32 s26, s24, 20971520
    s_add_u32 s27, s24, 37748736
    s_add_u32 s39, s23, 0x8000
    s_mov_b32 m0, s23
    s_nop 0
    buffer_load_dwordx4 v2, s[4:7], s26 offen offset:0 sc1 lds
    buffer_load_dwordx4 v2, s[4:7], s26 offen offset:1024 sc1 lds
    buffer_load_dwordx4 v2, s[4:7], s26 offen offset:2048 sc1 lds
    buffer_load_dwordx4 v2, s[4:7], s26 offen offset:3072 sc1 lds
    s_lshl_b32 s30, s17, 2
    s_add_u32 s30, s30, s22
    s_lshl_b32 s30, s30, 13
    s_add_u32 s30, s30, s24
    s_add_u32 s30, s30, 4194304
    s_add_u32 s33, s30, 4096
    s_mov_b32 m0, s39
    s_nop 0
    buffer_load_dwordx4 v2, s[4:7], s27 offen offset:0 sc1 lds
    buffer_load_dwordx4 v2, s[4:7], s27 offen offset:1024 sc1 lds
    buffer_load_dwordx4 v2, s[4:7], s27 offen offset:2048 sc1 lds
    buffer_load_dwordx4 v2, s[4:7], s27 offen offset:3072 sc1 lds
    s_lshr_b32 s57, s34, 1
    s_add_u32 s57, s57, 16
    v_mov_b32 v14, s57
    v_mov_b32 v15, s17
    v_mov_b32 v16, s35
    v_and_b32 v17, 1, v1
    v_cmp_eq_u32 vcc, 1, v17
    v_cndmask_b32 v16, v15, v16, vcc
    v_lshrrev_b32 v15, 1, v16
    v_lshrrev_b32 v18, 3, v14
    v_lshlrev_b32 v18, 6, v18
    v_and_b32 v14, 7, v14
    v_add_u32 v18, v18, v14
    v_lshl_add_u32 v18, v15, 3, v18
    v_lshlrev_b32 v18, 8, v18
    v_add_u32 v18, 117768256, v18
    v_and_b32 v16, 1, v16
    v_and_b32 v17, 2, v1
    v_add_u32 v16, v16, v17
    s_and_b32 s57, s34, 1
    s_lshl_b32 s57, s57, 2
    v_add_u32 v16, s57, v16
    v_lshl_add_u32 v18, v16, 2, v18
    s_nop 1
    v_mov_b32_dpp v21, v18 quad_perm:[1,1,3,3] row_mask:0xf bank_mask:0xf
    v_mov_b32_dpp v18, v18 quad_perm:[0,0,2,2] row_mask:0xf bank_mask:0xf
    v_mov_b32 v25, 0
    v_mov_b32 v12, 0
    s_and_b32 s57, s2, 7
    s_lshl_b32 s57, s57, 1
    s_bfe_u32 s58, s2, 0x10003
    s_add_u32 s57, s57, s58
    s_lshr_b32 s57, s57, 1
    v_mov_b32 v15, s57
    v_min_u32 v14, 13, v1
    v_lshrrev_b32 v13, 3, v14
    v_lshlrev_b32 v13, 6, v13
    v_and_b32 v14, 7, v14
    v_add_u32 v13, v13, v14
    v_lshl_add_u32 v13, v15, 3, v13
    v_lshlrev_b32 v13, 8, v13
    v_add_u32 v13, 117768320, v13
    s_cmp_eq_u32 s21, 0
    s_cbranch_scc0 Lqw
Lpoll_22:
    buffer_load_dword v19, v18, s[4:7], 0 offen sc1
    s_waitcnt vmcnt(0)
Lchk_24:
    v_cmp_eq_u32 vcc, 0, v19
    s_cbranch_vccz Lrdy_23
    s_sleep 8
    s_branch Lpoll_22
Lrdy_23:
    Lqw:
    s_barrier
    buffer_load_dwordx4 v[32:35], v5, s[4:7], s30 offen offset:0 sc1
    buffer_load_dwordx4 v[36:39], v5, s[4:7], s30 offen offset:1024 sc1
    buffer_load_dwordx4 v[40:43], v5, s[4:7], s30 offen offset:2048 sc1
    buffer_load_dwordx4 v[44:47], v5, s[4:7], s30 offen offset:3072 sc1
    buffer_load_dwordx4 v[48:51], v5, s[4:7], s33 offen offset:0 sc1
    buffer_load_dwordx4 v[52:55], v5, s[4:7], s33 offen offset:1024 sc1
    buffer_load_dwordx4 v[56:59], v5, s[4:7], s33 offen offset:2048 sc1
    buffer_load_dwordx4 v[60:63], v5, s[4:7], s33 offen offset:3072 sc1
    s_and_b32 s57, s2, 7
    s_lshl_b32 s57, s57, 1
    s_bfe_u32 s58, s2, 0x10003
    s_add_u32 s57, s57, s58
    s_lshl_b32 s57, s57, 2
    s_and_b32 s58, s21, 3
    s_add_u32 s57, s57, s58
    s_mul_i32 s57, s57, 372736
    s_lshr_b32 s58, s21, 2
    s_lshl_b32 s58, s58, 11
    s_add_u32 s57, s57, s58
    s_add_u32 s57, s57, 54525952
    v_lshlrev_b32 v18, 4, v1
    v_add_u32 v14, s57, v18
    s_bfe_u32 s57, s2, 0x20004
    s_mul_i32 s57, s57, 7
    s_add_u32 s60, s57, 64
    s_lshl_b32 s60, s60, 12
    s_mul_i32 s61, s57, 81920
    s_lshl_b32 s62, s21, 10
    s_lshr_b32 s58, s2, 6
    s_mul_i32 s58, s58, 320
    s_movk_i32 s59, 3277
    s_movk_i32 s63, 1280
    s_lshl_b32 s57, s21, 6
    s_add_u32 s57, s57, 0
    v_add_u32 v18, s57, v1
    v_mul_lo_u32 v19, v18, s59
    v_lshrrev_b32 v19, 16, v19
    v_mul_u32_u24 v20, 20, v19
    v_sub_u32 v18, v18, v20
    v_mul_lo_u32 v19, v19, s63
    v_lshl_add_u32 v18, v18, 4, v19
    v_add_u32 v15, s58, v18
    s_lshl_b32 s57, s21, 6
    s_add_u32 s57, s57, 512
    v_add_u32 v18, s57, v1
    v_mul_lo_u32 v19, v18, s59
    v_lshrrev_b32 v19, 16, v19
    v_mul_u32_u24 v20, 20, v19
    v_sub_u32 v18, v18, v20
    v_mul_lo_u32 v19, v19, s63
    v_lshl_add_u32 v18, v18, 4, v19
    v_add_u32 v16, s58, v18
    s_lshl_b32 s57, s21, 6
    s_add_u32 s57, s57, 1024
    v_add_u32 v18, s57, v1
    v_mul_lo_u32 v19, v18, s59
    v_lshrrev_b32 v19, 16, v19
    v_mul_u32_u24 v20, 20, v19
    v_sub_u32 v18, v18, v20
    v_mul_lo_u32 v19, v19, s63
    v_lshl_add_u32 v18, v18, 4, v19
    v_add_u32 v17, s58, v18
    s_cmp_lt_u32 s21, 4
    s_cbranch_scc1 1f
    v_mov_b32 v17, 0x7f000000
    1:
    s_lshl_b32 s30, s35, 2
    s_add_u32 s30, s30, s22
    s_lshl_b32 s30, s30, 13
    s_add_u32 s30, s30, s24
    s_add_u32 s56, s30, 4194304
    s_mov_b32 s48, s44
    s_and_b32 s49, s45, 0xffff
    s_mov_b32 s50, 5242880
    s_mov_b32 s51, 0x00020000
    s_mov_b32 s52, s46
    s_and_b32 s53, s47, 0xffff
    s_mov_b32 s54, 2211840
    s_mov_b32 s55, 0x00020000
    s_lshl_b32 s30, s20, 16
    v_add_u32 v3, s30, v5
    v_add_u32 v4, 0x8000, v3
    s_lshl_b32 s30, s22, 5
    s_lshl_b32 s33, s20, 6
    s_sub_i32 s30, s30, s33
    v_and_b32 v27, 31, v1
    v_add_u32 v24, s30, v27
    v_lshrrev_b32 v26, 5, v1
    v_lshlrev_b32 v26, 2, v26
    v_sub_u32 v24, v24, v26
    s_mov_b32 s19, s17
    s_mov_b32 s16, 0
    s_waitcnt vmcnt(0)
Lblk_25:
    v_mov_b32 v22, 0
    v_mov_b32 v23, 0
    s_mov_b32 s36, 0xf6800000
    s_nop 0
    v_mov_b32 v208, 0
    v_mov_b32 v209, 0
    v_mov_b32 v210, 0
    v_mov_b32 v211, 0
    v_mov_b32 v212, 0
    v_mov_b32 v213, 0
    v_mov_b32 v214, 0
    v_mov_b32 v215, 0
    v_mov_b32 v216, 0
    v_mov_b32 v217, 0
    v_mov_b32 v218, 0
    v_mov_b32 v219, 0
    v_mov_b32 v220, 0
    v_mov_b32 v221, 0
    v_mov_b32 v222, 0
    v_mov_b32 v223, 0
    s_lshl_b32 s30, s19, 2
    s_add_u32 s30, s30, s22
    s_mul_i32 s29, s30, 372736
    s_lshl_b32 s30, s34, 13
    s_add_u32 s29, s29, s30
    s_lshl_b32 s30, s20, 12
    s_add_u32 s29, s29, s30
    s_add_u32 s29, s29, 54525952
    s_lshl_b32 s30, s22, 13
    s_add_u32 s30, s30, 131072
    s_add_u32 s33, s16, s19
    s_and_b32 s33, s33, 1
    s_lshl_b32 s33, s33, 14
    s_add_u32 s33, s33, 0x8000
    s_lshr_b32 s32, s22, 1
    s_lshl_b32 s32, s32, 16
    s_add_u32 s33, s33, s32
    s_and_b32 s32, s22, 1
    s_lshl_b32 s32, s32, 13
    s_add_u32 s33, s33, s32
    s_cmp_eq_u32 s20, 0
    s_cselect_b32 s32, s30, s33
    s_cselect_b32 s33, s33, s30
    v_add_u32 v6, s32, v5
    v_add_u32 v7, s33, v5
    s_waitcnt vmcnt(4)
    s_barrier
    s_cmp_eq_u32 s20, 0
    s_cbranch_scc1 Ls_26
    s_barrier
Ls_26:
    ds_read_b128 v[64:67], v3 offset:0
    ds_read_b128 v[68:71], v3 offset:1024
    ds_read_b128 v[72:75], v3 offset:2048
    ds_read_b128 v[76:79], v3 offset:3072
    ds_read_b128 v[80:83], v3 offset:4096
    ds_read_b128 v[84:87], v3 offset:5120
    ds_read_b128 v[88:91], v3 offset:6144
    s_setprio 1
    s_waitcnt lgkmcnt(5)
    v_mfma_f32_32x32x16_bf16 v[96:111], v[64:67], v[32:35], v[208:223]
    ds_read_b128 v[92:95], v3 offset:7168
    s_add_u32 s16, s16, 1
    s_sub_u32 s33, s16, s31
    s_cmp_le_u32 s16, s17
    s_cselect_b32 s33, s16, s33
    v_mfma_f32_32x32x16_bf16 v[96:111], v[68:71], v[36:39], v[96:111]
    ds_read_b128 v[64:67], v3 offset:8192
    s_lshl_b32 s33, s33, 15
    s_add_u32 s33, s33, s24
    s_cmp_le_u32 s16, 16
    s_cselect_b32 s33, s33, 268435456
    s_waitcnt lgkmcnt(5)
    v_mfma_f32_32x32x16_bf16 v[96:111], v[72:75], v[40:43], v[96:111]
    ds_read_b128 v[68:71], v3 offset:9216
    s_add_u32 s27, s33, 37748736
    s_and_b32 s30, s16, 1
    s_lshl_b32 s30, s30, 14
    v_mfma_f32_32x32x16_bf16 v[96:111], v[76:79], v[44:47], v[96:111]
    ds_read_b128 v[72:75], v3 offset:10240
    s_add_u32 s38, s30, s23
    s_add_u32 s39, s38, 0x8000
    s_add_u32 s26, s33, 20971520
    s_waitcnt lgkmcnt(5)
    v_mfma_f32_32x32x16_bf16 v[96:111], v[80:83], v[48:51], v[96:111]
    ds_read_b128 v[76:79], v3 offset:11264
    v_mfma_f32_32x32x16_bf16 v[96:111], v[84:87], v[52:55], v[96:111]
    ds_read_b128 v[80:83], v3 offset:12288
    s_mov_b32 m0, s38
    s_nop 0
    buffer_load_dwordx4 v2, s[4:7], s26 offen offset:0 sc1 lds
    s_waitcnt lgkmcnt(5)
    v_mfma_f32_32x32x16_bf16 v[96:111], v[88:91], v[56:59], v[96:111]
    ds_read_b128 v[84:87], v3 offset:13312
    v_mfma_f32_32x32x16_bf16 v[96:111], v[92:95], v[60:63], v[96:111]
    ds_read_b128 v[88:91], v3 offset:14336
    buffer_load_dwordx4 v2, s[4:7], s26 offen offset:1024 sc1 lds
    s_waitcnt lgkmcnt(5)
    v_mfma_f32_32x32x16_bf16 v[112:127], v[64:67], v[32:35], v[208:223]
    ds_read_b128 v[92:95], v3 offset:15360
    v_mfma_f32_32x32x16_bf16 v[112:127], v[68:71], v[36:39], v[112:127]
    buffer_load_dwordx4 v2, s[4:7], s26 offen offset:2048 sc1 lds
    s_waitcnt lgkmcnt(4)
    v_mfma_f32_32x32x16_bf16 v[112:127], v[72:75], v[40:43], v[112:127]
    v_mfma_f32_32x32x16_bf16 v[112:127], v[76:79], v[44:47], v[112:127]
    buffer_load_dwordx4 v2, s[4:7], s26 offen offset:3072 sc1 lds
    s_waitcnt lgkmcnt(2)
    v_mfma_f32_32x32x16_bf16 v[112:127], v[80:83], v[48:51], v[112:127]
    v_mfma_f32_32x32x16_bf16 v[112:127], v[84:87], v[52:55], v[112:127]
    s_waitcnt lgkmcnt(0)
    v_mfma_f32_32x32x16_bf16 v[112:127], v[88:91], v[56:59], v[112:127]
    v_xor_b32 v3, 0x4000, v3
    v_mfma_f32_32x32x16_bf16 v[112:127], v[92:95], v[60:63], v[112:127]
    s_setprio 0
    s_waitcnt vmcnt(4)
    s_barrier
    s_mov_b32 s18, s19
    s_cmp_eq_u32 s18, 0
    s_cbranch_scc1 Lend_28
Lloop_27:
    s_cmp_gt_u32 s16, 8
    s_cbranch_scc1 Lst_r
    s_cmp_eq_u32 s16, 1
    s_cbranch_scc0 2f
    s_cmp_eq_u32 s68, 1
    s_cbranch_scc0 Lst_r
    buffer_store_dwordx4 v[224:227], v5, s[4:7], s64 offen offset:0 sc1
    buffer_store_dwordx4 v[228:231], v5, s[4:7], s64 offen offset:1024 sc1
    s_branch Lst_r
    2:
    s_cmp_eq_u32 s16, 2
    s_cbranch_scc0 2f
    s_cmp_eq_u32 s68, 1
    s_cbranch_scc0 Lst_r
    buffer_store_dwordx4 v[232:235], v5, s[4:7], s65 offen offset:0 sc1
    buffer_store_dwordx4 v[236:239], v5, s[4:7], s65 offen offset:1024 sc1
    s_branch Lst_r
    2:
    s_cmp_eq_u32 s16, 3
    s_cbranch_scc0 2f
    s_cmp_eq_u32 s68, 1
    s_cbranch_scc0 Lst_r
    buffer_store_dwordx4 v[240:243], v5, s[4:7], s66 offen offset:0 sc1
    buffer_store_dwordx4 v[244:247], v5, s[4:7], s66 offen offset:1024 sc1
    s_branch Lst_r
    2:
    s_cmp_eq_u32 s16, 4
    s_cbranch_scc0 2f
    s_cmp_eq_u32 s68, 1
    s_cbranch_scc0 Lst_r
    buffer_store_dwordx4 v[248:251], v5, s[4:7], s67 offen offset:0 sc1
    buffer_store_dwordx4 v[252:255], v5, s[4:7], s67 offen offset:1024 sc1
    s_branch Lst_r
    2:
    s_cmp_eq_u32 s16, 6
    s_cbranch_scc0 2f
    s_cmp_eq_u32 s21, 0
    s_cbranch_scc0 1f
    s_lshl_b32 s57, s2, 8
    s_add_u32 s57, s57, 117768320
    v_mov_b32 v18, 0
    v_mov_b32 v19, 1
    s_mov_b64 exec, 1
    buffer_store_dword v19, v18, s[4:7], s57 offen sc1
    s_mov_b64 exec, -1
    1:
    s_lshl_b32 s57, s2, 8
    s_lshl_b32 s58, s21, 2
    s_add_u32 s57, s57, s58
    s_add_u32 s57, s57, 117768256
    v_mov_b32 v18, 0
    v_mov_b32 v19, 1
    s_mov_b64 exec, 1
    buffer_store_dword v19, v18, s[4:7], s57 offen sc1
    s_mov_b64 exec, -1
    2:
    s_cmp_eq_u32 s16, 8
    s_cbranch_scc0 Lst_r
    buffer_load_dword v25, v21, s[4:7], 0 offen sc1
    buffer_load_dword v12, v13, s[4:7], 0 offen sc1
Lst_r:
    s_mov_b32 m0, s39
    s_nop 0
    buffer_load_dwordx4 v2, s[4:7], s27 offen offset:0 sc1 lds
    buffer_load_dwordx4 v2, s[4:7], s27 offen offset:1024 sc1 lds
    buffer_load_dwordx4 v2, s[4:7], s27 offen offset:2048 sc1 lds
    buffer_load_dwordx4 v2, s[4:7], s27 offen offset:3072 sc1 lds
    s_nop 3
    v_max3_f32 v26, v96, v97, v98
    v_max3_f32 v27, v99, v100, v101
    v_max3_f32 v26, v26, v102, v103
    v_max3_f32 v27, v27, v104, v105
    v_max3_f32 v26, v26, v106, v107
    v_max3_f32 v27, v27, v108, v109
    v_max3_f32 v26, v26, v110, v111
    v_max3_f32 v27, v27, v112, v113
    v_max3_f32 v26, v26, v114, v115
    v_max3_f32 v27, v27, v116, v117
    v_max3_f32 v26, v26, v118, v119
    v_max3_f32 v27, v27, v120, v121
    v_max3_f32 v26, v26, v122, v123
    v_max3_f32 v27, v27, v124, v125
    v_max3_f32 v26, v26, v126, v127
    v_max_f32 v26, v26, v27
    v_cmp_lt_f32 vcc, s36, v26
    s_cmp_lg_u64 vcc, 0
    s_cbranch_scc0 Lnr_29
    v_mov_b32 v27, v26
    s_nop 1
    v_permlane32_swap_b32 v26, v27
    s_nop 1
    v_max_f32 v26, v26, v27
    s_cmp_eq_u32 s36, 0x41000000
    s_cbranch_scc0 Lfirst_30
    v_max_f32 v26, 0, v26
    v_sub_f32 v27, 0, v26
    v_exp_f32 v27, v27
    s_nop 0
    v_mul_f32 v23, v23, v27
    v_mul_f32 v144, v144, v27
    v_mul_f32 v145, v145, v27
    v_mul_f32 v146, v146, v27
    v_mul_f32 v147, v147, v27
    v_mul_f32 v148, v148, v27
    v_mul_f32 v149, v149, v27
    v_mul_f32 v150, v150, v27
    v_mul_f32 v151, v151, v27
    v_mul_f32 v152, v152, v27
    v_mul_f32 v153, v153, v27
    v_mul_f32 v154, v154, v27
    v_mul_f32 v155, v155, v27
    v_mul_f32 v156, v156, v27
    v_mul_f32 v157, v157, v27
    v_mul_f32 v158, v158, v27
    v_mul_f32 v159, v159, v27
    v_mul_f32 v160, v160, v27
    v_mul_f32 v161, v161, v27
    v_mul_f32 v162, v162, v27
    v_mul_f32 v163, v163, v27
    v_mul_f32 v164, v164, v27
    v_mul_f32 v165, v165, v27
    v_mul_f32 v166, v166, v27
    v_mul_f32 v167, v167, v27
    v_mul_f32 v168, v168, v27
    v_mul_f32 v169, v169, v27
    v_mul_f32 v170, v170, v27
    v_mul_f32 v171, v171, v27
    v_mul_f32 v172, v172, v27
    v_mul_f32 v173, v173, v27
    v_mul_f32 v174, v174, v27
    v_mul_f32 v175, v175, v27
    v_mul_f32 v176, v176, v27
    v_mul_f32 v177, v177, v27
    v_mul_f32 v178, v178, v27
    v_mul_f32 v179, v179, v27
    v_mul_f32 v180, v180, v27
    v_mul_f32 v181, v181, v27
    v_mul_f32 v182, v182, v27
    v_mul_f32 v183, v183, v27
    v_mul_f32 v184, v184, v27
    v_mul_f32 v185, v185, v27
    v_mul_f32 v186, v186, v27
    v_mul_f32 v187, v187, v27
    v_mul_f32 v188, v188, v27
    v_mul_f32 v189, v189, v27
    v_mul_f32 v190, v190, v27
    v_mul_f32 v191, v191, v27
    v_mul_f32 v192, v192, v27
    v_mul_f32 v193, v193, v27
    v_mul_f32 v194, v194, v27
    v_mul_f32 v195, v195, v27
    v_mul_f32 v196, v196, v27
    v_mul_f32 v197, v197, v27
    v_mul_f32 v198, v198, v27
    v_mul_f32 v199, v199, v27
    v_mul_f32 v200, v200, v27
    v_mul_f32 v201, v201, v27
    v_mul_f32 v202, v202, v27
    v_mul_f32 v203, v203, v27
    v_mul_f32 v204, v204, v27
    v_mul_f32 v205, v205, v27
    v_mul_f32 v206, v206, v27
    v_mul_f32 v207, v207, v27
    s_branch Lrj_31
Lfirst_30:
    v_mov_b32 v144, 0
    v_mov_b32 v145, 0
    v_mov_b32 v146, 0
    v_mov_b32 v147, 0
    v_mov_b32 v148, 0
    v_mov_b32 v149, 0
    v_mov_b32 v150, 0
    v_mov_b32 v151, 0
    v_mov_b32 v152, 0
    v_mov_b32 v153, 0
    v_mov_b32 v154, 0
    v_mov_b32 v155, 0
    v_mov_b32 v156, 0
    v_mov_b32 v157, 0
    v_mov_b32 v158, 0
    v_mov_b32 v159, 0
    v_mov_b32 v160, 0
    v_mov_b32 v161, 0
    v_mov_b32 v162, 0
    v_mov_b32 v163, 0
    v_mov_b32 v164, 0
    v_mov_b32 v165, 0
    v_mov_b32 v166, 0
    v_mov_b32 v167, 0
    v_mov_b32 v168, 0
    v_mov_b32 v169, 0
    v_mov_b32 v170, 0
    v_mov_b32 v171, 0
    v_mov_b32 v172, 0
    v_mov_b32 v173, 0
    v_mov_b32 v174, 0
    v_mov_b32 v175, 0
    v_mov_b32 v176, 0
    v_mov_b32 v177, 0
    v_mov_b32 v178, 0
    v_mov_b32 v179, 0
    v_mov_b32 v180, 0
    v_mov_b32 v181, 0
    v_mov_b32 v182, 0
    v_mov_b32 v183, 0
    v_mov_b32 v184, 0
    v_mov_b32 v185, 0
    v_mov_b32 v186, 0
    v_mov_b32 v187, 0
    v_mov_b32 v188, 0
    v_mov_b32 v189, 0
    v_mov_b32 v190, 0
    v_mov_b32 v191, 0
    v_mov_b32 v192, 0
    v_mov_b32 v193, 0
    v_mov_b32 v194, 0
    v_mov_b32 v195, 0
    v_mov_b32 v196, 0
    v_mov_b32 v197, 0
    v_mov_b32 v198, 0
    v_mov_b32 v199, 0
    v_mov_b32 v200, 0
    v_mov_b32 v201, 0
    v_mov_b32 v202, 0
    v_mov_b32 v203, 0
    v_mov_b32 v204, 0
    v_mov_b32 v205, 0
    v_mov_b32 v206, 0
    v_mov_b32 v207, 0
    s_mov_b32 s36, 0x41000000
Lrj_31:
    v_add_f32 v22, v22, v26
    v_sub_f32 v96, v96, v26
    v_sub_f32 v97, v97, v26
    v_sub_f32 v98, v98, v26
    v_sub_f32 v99, v99, v26
    v_sub_f32 v100, v100, v26
    v_sub_f32 v101, v101, v26
    v_sub_f32 v102, v102, v26
    v_sub_f32 v103, v103, v26
    v_sub_f32 v104, v104, v26
    v_sub_f32 v105, v105, v26
    v_sub_f32 v106, v106, v26
    v_sub_f32 v107, v107, v26
    v_sub_f32 v108, v108, v26
    v_sub_f32 v109, v109, v26
    v_sub_f32 v110, v110, v26
    v_sub_f32 v111, v111, v26
    v_sub_f32 v112, v112, v26
    v_sub_f32 v113, v113, v26
    v_sub_f32 v114, v114, v26
    v_sub_f32 v115, v115, v26
    v_sub_f32 v116, v116, v26
    v_sub_f32 v117, v117, v26
    v_sub_f32 v118, v118, v26
    v_sub_f32 v119, v119, v26
    v_sub_f32 v120, v120, v26
    v_sub_f32 v121, v121, v26
    v_sub_f32 v122, v122, v26
    v_sub_f32 v123, v123, v26
    v_sub_f32 v124, v124, v26
    v_sub_f32 v125, v125, v26
    v_sub_f32 v126, v126, v26
    v_sub_f32 v127, v127, v26
    v_sub_f32 v208, 0, v22
    v_sub_f32 v209, 0, v22
    v_sub_f32 v210, 0, v22
    v_sub_f32 v211, 0, v22
    v_sub_f32 v212, 0, v22
    v_sub_f32 v213, 0, v22
    v_sub_f32 v214, 0, v22
    v_sub_f32 v215, 0, v22
    v_sub_f32 v216, 0, v22
    v_sub_f32 v217, 0, v22
    v_sub_f32 v218, 0, v22
    v_sub_f32 v219, 0, v22
    v_sub_f32 v220, 0, v22
    v_sub_f32 v221, 0, v22
    v_sub_f32 v222, 0, v22
    v_sub_f32 v223, 0, v22
Lnr_29:
    v_exp_f32 v96, v96
    v_exp_f32 v97, v97
    v_exp_f32 v98, v98
    v_exp_f32 v99, v99
    v_exp_f32 v100, v100
    v_exp_f32 v101, v101
    v_exp_f32 v102, v102
    v_exp_f32 v103, v103
    v_exp_f32 v104, v104
    v_exp_f32 v105, v105
    v_exp_f32 v106, v106
    v_exp_f32 v107, v107
    v_exp_f32 v108, v108
    v_exp_f32 v109, v109
    v_exp_f32 v110, v110
    v_exp_f32 v111, v111
    v_cvt_pk_bf16_f32 v128, v96, v97
    v_cvt_pk_bf16_f32 v129, v98, v99
    v_cvt_pk_bf16_f32 v130, v100, v101
    v_cvt_pk_bf16_f32 v131, v102, v103
    v_exp_f32 v112, v112
    v_exp_f32 v113, v113
    v_exp_f32 v114, v114
    v_exp_f32 v115, v115
    v_exp_f32 v116, v116
    v_exp_f32 v117, v117
    v_exp_f32 v118, v118
    v_exp_f32 v119, v119
    v_cvt_pk_bf16_f32 v132, v104, v105
    v_cvt_pk_bf16_f32 v133, v106, v107
    v_cvt_pk_bf16_f32 v134, v108, v109
    v_cvt_pk_bf16_f32 v135, v110, v111
    v_exp_f32 v120, v120
    v_exp_f32 v121, v121
    v_exp_f32 v122, v122
    v_exp_f32 v123, v123
    v_exp_f32 v124, v124
    v_exp_f32 v125, v125
    v_exp_f32 v126, v126
    v_exp_f32 v127, v127
    v_cvt_pk_bf16_f32 v136, v112, v113
    v_cvt_pk_bf16_f32 v137, v114, v115
    v_cvt_pk_bf16_f32 v138, v116, v117
    v_cvt_pk_bf16_f32 v139, v118, v119
    ds_read_b128 v[64:67], v4 offset:0
    ds_read_b128 v[68:71], v4 offset:1024
    ds_read_b128 v[72:75], v4 offset:2048
    ds_read_b128 v[76:79], v4 offset:3072
    ds_read_b128 v[80:83], v4 offset:4096
    ds_read_b128 v[84:87], v4 offset:5120
    ds_read_b128 v[88:91], v4 offset:6144
    v_cvt_pk_bf16_f32 v140, v120, v121
    v_cvt_pk_bf16_f32 v141, v122, v123
    v_cvt_pk_bf16_f32 v142, v124, v125
    v_cvt_pk_bf16_f32 v143, v126, v127
    s_waitcnt vmcnt(4)
    s_barrier
    s_setprio 1
    s_waitcnt lgkmcnt(5)
    v_mfma_f32_32x32x16_bf16 v[144:159], v[64:67], v[128:131], v[144:159]
    ds_read_b128 v[92:95], v4 offset:7168
    s_add_u32 s16, s16, 1
    s_sub_u32 s33, s16, s31
    s_cmp_le_u32 s16, s17
    s_cselect_b32 s33, s16, s33
    v_add_f32 v23, v23, v96
    v_add_f32 v28, v97, v98
    v_mfma_f32_32x32x16_bf16 v[144:159], v[68:71], v[132:135], v[144:159]
    ds_read_b128 v[64:67], v4 offset:8192
    s_lshl_b32 s33, s33, 15
    s_add_u32 s33, s33, s24
    s_cmp_le_u32 s16, 16
    s_cselect_b32 s33, s33, 268435456
    v_add_f32 v29, v99, v100
    v_add_f32 v23, v23, v101
    s_waitcnt lgkmcnt(5)
    v_mfma_f32_32x32x16_bf16 v[144:159], v[72:75], v[136:139], v[144:159]
    ds_read_b128 v[68:71], v4 offset:9216
    s_add_u32 s27, s33, 37748736
    s_and_b32 s30, s16, 1
    s_lshl_b32 s30, s30, 14
    v_add_f32 v28, v28, v102
    v_add_f32 v29, v29, v103
    v_mfma_f32_32x32x16_bf16 v[144:159], v[76:79], v[140:143], v[144:159]
    ds_read_b128 v[72:75], v4 offset:10240
    s_add_u32 s38, s30, s23
    s_add_u32 s39, s38, 0x8000
    s_add_u32 s26, s33, 20971520
    v_add_f32 v23, v23, v104
    v_add_f32 v28, v28, v105
    s_waitcnt lgkmcnt(5)
    v_mfma_f32_32x32x16_bf16 v[160:175], v[80:83], v[128:131], v[160:175]
    ds_read_b128 v[76:79], v4 offset:11264
    v_add_f32 v29, v29, v106
    v_add_f32 v23, v23, v107
    v_mfma_f32_32x32x16_bf16 v[160:175], v[84:87], v[132:135], v[160:175]
    ds_read_b128 v[80:83], v4 offset:12288
    v_add_f32 v28, v28, v108
    v_add_f32 v29, v29, v109
    s_waitcnt lgkmcnt(5)
    v_mfma_f32_32x32x16_bf16 v[160:175], v[88:91], v[136:139], v[160:175]
    ds_read_b128 v[84:87], v4 offset:13312
    v_add_f32 v23, v23, v110
    v_add_f32 v28, v28, v111
    v_mfma_f32_32x32x16_bf16 v[160:175], v[92:95], v[140:143], v[160:175]
    ds_read_b128 v[88:91], v4 offset:14336
    v_add_f32 v29, v29, v112
    v_add_f32 v23, v23, v113
    s_waitcnt lgkmcnt(5)
    v_mfma_f32_32x32x16_bf16 v[176:191], v[64:67], v[128:131], v[176:191]
    ds_read_b128 v[92:95], v4 offset:15360
    v_add_f32 v28, v28, v114
    v_add_f32 v29, v29, v115
    v_mfma_f32_32x32x16_bf16 v[176:191], v[68:71], v[132:135], v[176:191]
    ds_read_b128 v[64:67], v3 offset:0
    v_add_f32 v23, v23, v116
    v_add_f32 v28, v28, v117
    s_waitcnt lgkmcnt(5)
    v_mfma_f32_32x32x16_bf16 v[176:191], v[72:75], v[136:139], v[176:191]
    ds_read_b128 v[68:71], v3 offset:1024
    v_add_f32 v29, v29, v118
    v_add_f32 v23, v23, v119
    v_xor_b32 v4, 0x4000, v4
    v_mfma_f32_32x32x16_bf16 v[176:191], v[76:79], v[140:143], v[176:191]
    ds_read_b128 v[72:75], v3 offset:2048
    v_add_f32 v28, v28, v120
    v_add_f32 v29, v29, v121
    s_waitcnt lgkmcnt(5)
    v_mfma_f32_32x32x16_bf16 v[192:207], v[80:83], v[128:131], v[192:207]
    ds_read_b128 v[76:79], v3 offset:3072
    v_add_f32 v23, v23, v122
    v_add_f32 v28, v28, v123
    v_mfma_f32_32x32x16_bf16 v[192:207], v[84:87], v[132:135], v[192:207]
    ds_read_b128 v[80:83], v3 offset:4096
    v_add_f32 v29, v29, v124
    v_add_f32 v23, v23, v125
    s_waitcnt lgkmcnt(5)
    v_mfma_f32_32x32x16_bf16 v[192:207], v[88:91], v[136:139], v[192:207]
    ds_read_b128 v[84:87], v3 offset:5120
    v_add_f32 v28, v28, v126
    v_add_f32 v29, v29, v127
    v_mfma_f32_32x32x16_bf16 v[192:207], v[92:95], v[140:143], v[192:207]
    ds_read_b128 v[88:91], v3 offset:6144
    s_waitcnt lgkmcnt(5)
    v_mfma_f32_32x32x16_bf16 v[96:111], v[64:67], v[32:35], v[208:223]
    ds_read_b128 v[92:95], v3 offset:7168
    s_mov_b32 m0, s38
    s_nop 0
    buffer_load_dwordx4 v2, s[4:7], s26 offen offset:0 sc1 lds
    v_add_f32 v28, v28, v29
    v_mfma_f32_32x32x16_bf16 v[96:111], v[68:71], v[36:39], v[96:111]
    ds_read_b128 v[64:67], v3 offset:8192
    v_add_f32 v23, v23, v28
    s_waitcnt lgkmcnt(5)
    v_mfma_f32_32x32x16_bf16 v[96:111], v[72:75], v[40:43], v[96:111]
    ds_read_b128 v[68:71], v3 offset:9216
    buffer_load_dwordx4 v2, s[4:7], s26 offen offset:1024 sc1 lds
    v_mfma_f32_32x32x16_bf16 v[96:111], v[76:79], v[44:47], v[96:111]
    ds_read_b128 v[72:75], v3 offset:10240
    s_waitcnt lgkmcnt(5)
    v_mfma_f32_32x32x16_bf16 v[96:111], v[80:83], v[48:51], v[96:111]
    ds_read_b128 v[76:79], v3 offset:11264
    buffer_load_dwordx4 v2, s[4:7], s26 offen offset:2048 sc1 lds
    v_mfma_f32_32x32x16_bf16 v[96:111], v[84:87], v[52:55], v[96:111]
    ds_read_b128 v[80:83], v3 offset:12288
    s_waitcnt lgkmcnt(5)
    v_mfma_f32_32x32x16_bf16 v[96:111], v[88:91], v[56:59], v[96:111]
    ds_read_b128 v[84:87], v3 offset:13312
    buffer_load_dwordx4 v2, s[4:7], s26 offen offset:3072 sc1 lds
    v_mfma_f32_32x32x16_bf16 v[96:111], v[92:95], v[60:63], v[96:111]
    ds_read_b128 v[88:91], v3 offset:14336
    s_waitcnt lgkmcnt(5)
    v_mfma_f32_32x32x16_bf16 v[112:127], v[64:67], v[32:35], v[208:223]
    ds_read_b128 v[92:95], v3 offset:15360
    v_mfma_f32_32x32x16_bf16 v[112:127], v[68:71], v[36:39], v[112:127]
    s_waitcnt lgkmcnt(4)
    v_mfma_f32_32x32x16_bf16 v[112:127], v[72:75], v[40:43], v[112:127]
    v_mfma_f32_32x32x16_bf16 v[112:127], v[76:79], v[44:47], v[112:127]
    s_waitcnt lgkmcnt(2)
    v_mfma_f32_32x32x16_bf16 v[112:127], v[80:83], v[48:51], v[112:127]
    v_mfma_f32_32x32x16_bf16 v[112:127], v[84:87], v[52:55], v[112:127]
    s_waitcnt lgkmcnt(0)
    v_mfma_f32_32x32x16_bf16 v[112:127], v[88:91], v[56:59], v[112:127]
    v_xor_b32 v3, 0x4000, v3
    v_mfma_f32_32x32x16_bf16 v[112:127], v[92:95], v[60:63], v[112:127]
    s_setprio 0
    s_waitcnt vmcnt(4)
    s_barrier
    s_sub_u32 s18, s18, 1
    s_cmp_lg_u32 s18, 0
    s_cbranch_scc1 Lloop_27
Lend_28:
    s_branch Lchk_34
Lpoll_32:
    buffer_load_dword v25, v21, s[4:7], 0 offen sc1
    s_waitcnt vmcnt(0)
Lchk_34:
    v_cmp_eq_u32 vcc, 0, v25
    s_cbranch_vccz Lrdy_33
    s_sleep 4
    s_branch Lpoll_32
Lrdy_33:
    s_mov_b32 m0, s39
    s_nop 0
    buffer_load_dwordx4 v2, s[4:7], s27 offen offset:0 sc1 lds
    buffer_load_dwordx4 v2, s[4:7], s27 offen offset:1024 sc1 lds
    buffer_load_dwordx4 v2, s[4:7], s27 offen offset:2048 sc1 lds
    buffer_load_dwordx4 v2, s[4:7], s27 offen offset:3072 sc1 lds
    v_lshlrev_b32 v26, 6, v0
    s_mul_i32 s30, s2, 20480
    s_mul_i32 s33, s2, 8640
    buffer_load_dword v8, v26, s[48:51], s30 offen
    buffer_load_dword v9, v26, s[52:55], s33 offen
    s_add_u32 s33, s56, 4096
    buffer_load_dwordx4 v[32:35], v5, s[4:7], s56 offen offset:0 sc1
    buffer_load_dwordx4 v[36:39], v5, s[4:7], s56 offen offset:1024 sc1
    buffer_load_dwordx4 v[40:43], v5, s[4:7], s56 offen offset:2048 sc1
    buffer_load_dwordx4 v[44:47], v5, s[4:7], s56 offen offset:3072 sc1
    buffer_load_dwordx4 v[48:51], v5, s[4:7], s33 offen offset:0 sc1
    buffer_load_dwordx4 v[52:55], v5, s[4:7], s33 offen offset:1024 sc1
    buffer_load_dwordx4 v[56:59], v5, s[4:7], s33 offen offset:2048 sc1
    buffer_load_dwordx4 v[60:63], v5, s[4:7], s33 offen offset:3072 sc1
    s_mov_b32 s56, 268435456
    v_mov_b32 v26, 0xf1800000
    v_cmp_gt_i32 s[40:41], 0, v24
    v_cmp_gt_i32 s[42:43], 1, v24
    v_cmp_gt_i32 s[44:45], 2, v24
    v_cmp_gt_i32 s[46:47], 3, v24
    v_cndmask_b32 v96, v96, v26, s[40:41]
    v_cndmask_b32 v97, v97, v26, s[42:43]
    v_cndmask_b32 v98, v98, v26, s[44:45]
    v_cndmask_b32 v99, v99, v26, s[46:47]
    v_cmp_gt_i32 s[40:41], 8, v24
    v_cmp_gt_i32 s[42:43], 9, v24
    v_cmp_gt_i32 s[44:45], 10, v24
    v_cmp_gt_i32 s[46:47], 11, v24
    v_cndmask_b32 v100, v100, v26, s[40:41]
    v_cndmask_b32 v101, v101, v26, s[42:43]
    v_cndmask_b32 v102, v102, v26, s[44:45]
    v_cndmask_b32 v103, v103, v26, s[46:47]
    v_cmp_gt_i32 s[40:41], 16, v24
    v_cmp_gt_i32 s[42:43], 17, v24
    v_cmp_gt_i32 s[44:45], 18, v24
    v_cmp_gt_i32 s[46:47], 19, v24
    v_cndmask_b32 v104, v104, v26, s[40:41]
    v_cndmask_b32 v105, v105, v26, s[42:43]
    v_cndmask_b32 v106, v106, v26, s[44:45]
    v_cndmask_b32 v107, v107, v26, s[46:47]
    v_cmp_gt_i32 s[40:41], 24, v24
    v_cmp_gt_i32 s[42:43], 25, v24
    v_cmp_gt_i32 s[44:45], 26, v24
    v_cmp_gt_i32 s[46:47], 27, v24
    v_cndmask_b32 v108, v108, v26, s[40:41]
    v_cndmask_b32 v109, v109, v26, s[42:43]
    v_cndmask_b32 v110, v110, v26, s[44:45]
    v_cndmask_b32 v111, v111, v26, s[46:47]
    v_cmp_gt_i32 s[40:41], 32, v24
    v_cmp_gt_i32 s[42:43], 33, v24
    v_cmp_gt_i32 s[44:45], 34, v24
    v_cmp_gt_i32 s[46:47], 35, v24
    v_cndmask_b32 v112, v112, v26, s[40:41]
    v_cndmask_b32 v113, v113, v26, s[42:43]
    v_cndmask_b32 v114, v114, v26, s[44:45]
    v_cndmask_b32 v115, v115, v26, s[46:47]
    v_cmp_gt_i32 s[40:41], 40, v24
    v_cmp_gt_i32 s[42:43], 41, v24
    v_cmp_gt_i32 s[44:45], 42, v24
    v_cmp_gt_i32 s[46:47], 43, v24
    v_cndmask_b32 v116, v116, v26, s[40:41]
    v_cndmask_b32 v117, v117, v26, s[42:43]
    v_cndmask_b32 v118, v118, v26, s[44:45]
    v_cndmask_b32 v119, v119, v26, s[46:47]
    v_cmp_gt_i32 s[40:41], 48, v24
    v_cmp_gt_i32 s[42:43], 49, v24
    v_cmp_gt_i32 s[44:45], 50, v24
    v_cmp_gt_i32 s[46:47], 51, v24
    v_cndmask_b32 v120, v120, v26, s[40:41]
    v_cndmask_b32 v121, v121, v26, s[42:43]
    v_cndmask_b32 v122, v122, v26, s[44:45]
    v_cndmask_b32 v123, v123, v26, s[46:47]
    v_cmp_gt_i32 s[40:41], 56, v24
    v_cmp_gt_i32 s[42:43], 57, v24
    v_cmp_gt_i32 s[44:45], 58, v24
    v_cmp_gt_i32 s[46:47], 59, v24
    v_cndmask_b32 v124, v124, v26, s[40:41]
    v_cndmask_b32 v125, v125, v26, s[42:43]
    v_cndmask_b32 v126, v126, v26, s[44:45]
    v_cndmask_b32 v127, v127, v26, s[46:47]
    v_max3_f32 v26, v96, v97, v98
    v_max3_f32 v27, v99, v100, v101
    v_max3_f32 v26, v26, v102, v103
    v_max3_f32 v27, v27, v104, v105
    v_max3_f32 v26, v26, v106, v107
    v_max3_f32 v27, v27, v108, v109
    v_max3_f32 v26, v26, v110, v111
    v_max3_f32 v27, v27, v112, v113
    v_max3_f32 v26, v26, v114, v115
    v_max3_f32 v27, v27, v116, v117
    v_max3_f32 v26, v26, v118, v119
    v_max3_f32 v27, v27, v120, v121
    v_max3_f32 v26, v26, v122, v123
    v_max3_f32 v27, v27, v124, v125
    v_max3_f32 v26, v26, v126, v127
    v_max_f32 v26, v26, v27
    v_cmp_lt_f32 vcc, s36, v26
    s_cmp_lg_u64 vcc, 0
    s_cbranch_scc0 Lnr_35
    v_mov_b32 v27, v26
    s_nop 1
    v_permlane32_swap_b32 v26, v27
    s_nop 1
    v_max_f32 v26, v26, v27
    s_cmp_eq_u32 s36, 0x41000000
    s_cbranch_scc0 Lfirst_36
    v_max_f32 v26, 0, v26
    v_sub_f32 v27, 0, v26
    v_exp_f32 v27, v27
    s_nop 0
    v_mul_f32 v23, v23, v27
    v_mul_f32 v144, v144, v27
    v_mul_f32 v145, v145, v27
    v_mul_f32 v146, v146, v27
    v_mul_f32 v147, v147, v27
    v_mul_f32 v148, v148, v27
    v_mul_f32 v149, v149, v27
    v_mul_f32 v150, v150, v27
    v_mul_f32 v151, v151, v27
    v_mul_f32 v152, v152, v27
    v_mul_f32 v153, v153, v27
    v_mul_f32 v154, v154, v27
    v_mul_f32 v155, v155, v27
    v_mul_f32 v156, v156, v27
    v_mul_f32 v157, v157, v27
    v_mul_f32 v158, v158, v27
    v_mul_f32 v159, v159, v27
    v_mul_f32 v160, v160, v27
    v_mul_f32 v161, v161, v27
    v_mul_f32 v162, v162, v27
    v_mul_f32 v163, v163, v27
    v_mul_f32 v164, v164, v27
    v_mul_f32 v165, v165, v27
    v_mul_f32 v166, v166, v27
    v_mul_f32 v167, v167, v27
    v_mul_f32 v168, v168, v27
    v_mul_f32 v169, v169, v27
    v_mul_f32 v170, v170, v27
    v_mul_f32 v171, v171, v27
    v_mul_f32 v172, v172, v27
    v_mul_f32 v173, v173, v27
    v_mul_f32 v174, v174, v27
    v_mul_f32 v175, v175, v27
    v_mul_f32 v176, v176, v27
    v_mul_f32 v177, v177, v27
    v_mul_f32 v178, v178, v27
    v_mul_f32 v179, v179, v27
    v_mul_f32 v180, v180, v27
    v_mul_f32 v181, v181, v27
    v_mul_f32 v182, v182, v27
    v_mul_f32 v183, v183, v27
    v_mul_f32 v184, v184, v27
    v_mul_f32 v185, v185, v27
    v_mul_f32 v186, v186, v27
    v_mul_f32 v187, v187, v27
    v_mul_f32 v188, v188, v27
    v_mul_f32 v189, v189, v27
    v_mul_f32 v190, v190, v27
    v_mul_f32 v191, v191, v27
    v_mul_f32 v192, v192, v27
    v_mul_f32 v193, v193, v27
    v_mul_f32 v194, v194, v27
    v_mul_f32 v195, v195, v27
    v_mul_f32 v196, v196, v27
    v_mul_f32 v197, v197, v27
    v_mul_f32 v198, v198, v27
    v_mul_f32 v199, v199, v27
    v_mul_f32 v200, v200, v27
    v_mul_f32 v201, v201, v27
    v_mul_f32 v202, v202, v27
    v_mul_f32 v203, v203, v27
    v_mul_f32 v204, v204, v27
    v_mul_f32 v205, v205, v27
    v_mul_f32 v206, v206, v27
    v_mul_f32 v207, v207, v27
    s_branch Lrj_37
Lfirst_36:
    v_mov_b32 v144, 0
    v_mov_b32 v145, 0
    v_mov_b32 v146, 0
    v_mov_b32 v147, 0
    v_mov_b32 v148, 0
    v_mov_b32 v149, 0
    v_mov_b32 v150, 0
    v_mov_b32 v151, 0
    v_mov_b32 v152, 0
    v_mov_b32 v153, 0
    v_mov_b32 v154, 0
    v_mov_b32 v155, 0
    v_mov_b32 v156, 0
    v_mov_b32 v157, 0
    v_mov_b32 v158, 0
    v_mov_b32 v159, 0
    v_mov_b32 v160, 0
    v_mov_b32 v161, 0
    v_mov_b32 v162, 0
    v_mov_b32 v163, 0
    v_mov_b32 v164, 0
    v_mov_b32 v165, 0
    v_mov_b32 v166, 0
    v_mov_b32 v167, 0
    v_mov_b32 v168, 0
    v_mov_b32 v169, 0
    v_mov_b32 v170, 0
    v_mov_b32 v171, 0
    v_mov_b32 v172, 0
    v_mov_b32 v173, 0
    v_mov_b32 v174, 0
    v_mov_b32 v175, 0
    v_mov_b32 v176, 0
    v_mov_b32 v177, 0
    v_mov_b32 v178, 0
    v_mov_b32 v179, 0
    v_mov_b32 v180, 0
    v_mov_b32 v181, 0
    v_mov_b32 v182, 0
    v_mov_b32 v183, 0
    v_mov_b32 v184, 0
    v_mov_b32 v185, 0
    v_mov_b32 v186, 0
    v_mov_b32 v187, 0
    v_mov_b32 v188, 0
    v_mov_b32 v189, 0
    v_mov_b32 v190, 0
    v_mov_b32 v191, 0
    v_mov_b32 v192, 0
    v_mov_b32 v193, 0
    v_mov_b32 v194, 0
    v_mov_b32 v195, 0
    v_mov_b32 v196, 0
    v_mov_b32 v197, 0
    v_mov_b32 v198, 0
    v_mov_b32 v199, 0
    v_mov_b32 v200, 0
    v_mov_b32 v201, 0
    v_mov_b32 v202, 0
    v_mov_b32 v203, 0
    v_mov_b32 v204, 0
    v_mov_b32 v205, 0
    v_mov_b32 v206, 0
    v_mov_b32 v207, 0
    s_mov_b32 s36, 0x41000000
Lrj_37:
    v_add_f32 v22, v22, v26
    v_sub_f32 v96, v96, v26
    v_sub_f32 v97, v97, v26
    v_sub_f32 v98, v98, v26
    v_sub_f32 v99, v99, v26
    v_sub_f32 v100, v100, v26
    v_sub_f32 v101, v101, v26
    v_sub_f32 v102, v102, v26
    v_sub_f32 v103, v103, v26
    v_sub_f32 v104, v104, v26
    v_sub_f32 v105, v105, v26
    v_sub_f32 v106, v106, v26
    v_sub_f32 v107, v107, v26
    v_sub_f32 v108, v108, v26
    v_sub_f32 v109, v109, v26
    v_sub_f32 v110, v110, v26
    v_sub_f32 v111, v111, v26
    v_sub_f32 v112, v112, v26
    v_sub_f32 v113, v113, v26
    v_sub_f32 v114, v114, v26
    v_sub_f32 v115, v115, v26
    v_sub_f32 v116, v116, v26
    v_sub_f32 v117, v117, v26
    v_sub_f32 v118, v118, v26
    v_sub_f32 v119, v119, v26
    v_sub_f32 v120, v120, v26
    v_sub_f32 v121, v121, v26
    v_sub_f32 v122, v122, v26
    v_sub_f32 v123, v123, v26
    v_sub_f32 v124, v124, v26
    v_sub_f32 v125, v125, v26
    v_sub_f32 v126, v126, v26
    v_sub_f32 v127, v127, v26
    v_sub_f32 v208, 0, v22
    v_sub_f32 v209, 0, v22
    v_sub_f32 v210, 0, v22
    v_sub_f32 v211, 0, v22
    v_sub_f32 v212, 0, v22
    v_sub_f32 v213, 0, v22
    v_sub_f32 v214, 0, v22
    v_sub_f32 v215, 0, v22
    v_sub_f32 v216, 0, v22
    v_sub_f32 v217, 0, v22
    v_sub_f32 v218, 0, v22
    v_sub_f32 v219, 0, v22
    v_sub_f32 v220, 0, v22
    v_sub_f32 v221, 0, v22
    v_sub_f32 v222, 0, v22
    v_sub_f32 v223, 0, v22
Lnr_35:
    v_exp_f32 v96, v96
    v_exp_f32 v97, v97
    v_exp_f32 v98, v98
    v_exp_f32 v99, v99
    v_exp_f32 v100, v100
    v_exp_f32 v101, v101
    v_exp_f32 v102, v102
    v_exp_f32 v103, v103
    v_exp_f32 v104, v104
    v_exp_f32 v105, v105
    v_exp_f32 v106, v106
    v_exp_f32 v107, v107
    v_exp_f32 v108, v108
    v_exp_f32 v109, v109
    v_exp_f32 v110, v110
    v_exp_f32 v111, v111
    v_cvt_pk_bf16_f32 v128, v96, v97
    v_cvt_pk_bf16_f32 v129, v98, v99
    v_cvt_pk_bf16_f32 v130, v100, v101
    v_cvt_pk_bf16_f32 v131, v102, v103
    v_exp_f32 v112, v112
    v_exp_f32 v113, v113
    v_exp_f32 v114, v114
    v_exp_f32 v115, v115
    v_exp_f32 v116, v116
    v_exp_f32 v117, v117
    v_exp_f32 v118, v118
    v_exp_f32 v119, v119
    v_cvt_pk_bf16_f32 v132, v104, v105
    v_cvt_pk_bf16_f32 v133, v106, v107
    v_cvt_pk_bf16_f32 v134, v108, v109
    v_cvt_pk_bf16_f32 v135, v110, v111
    v_exp_f32 v120, v120
    v_exp_f32 v121, v121
    v_exp_f32 v122, v122
    v_exp_f32 v123, v123
    v_exp_f32 v124, v124
    v_exp_f32 v125, v125
    v_exp_f32 v126, v126
    v_exp_f32 v127, v127
    v_cvt_pk_bf16_f32 v136, v112, v113
    v_cvt_pk_bf16_f32 v137, v114, v115
    v_cvt_pk_bf16_f32 v138, v116, v117
    v_cvt_pk_bf16_f32 v139, v118, v119
    ds_read_b128 v[64:67], v4 offset:0
    ds_read_b128 v[68:71], v4 offset:1024
    ds_read_b128 v[72:75], v4 offset:2048
    ds_read_b128 v[76:79], v4 offset:3072
    ds_read_b128 v[80:83], v4 offset:4096
    ds_read_b128 v[84:87], v4 offset:5120
    ds_read_b128 v[88:91], v4 offset:6144
    v_cvt_pk_bf16_f32 v140, v120, v121
    v_cvt_pk_bf16_f32 v141, v122, v123
    v_cvt_pk_bf16_f32 v142, v124, v125
    v_cvt_pk_bf16_f32 v143, v126, v127
    v_add_f32 v23, v23, v96
    v_add_f32 v28, v97, v98
    v_add_f32 v29, v99, v100
    v_add_f32 v23, v23, v101
    v_add_f32 v28, v28, v102
    v_add_f32 v29, v29, v103
    v_add_f32 v23, v23, v104
    v_add_f32 v28, v28, v105
    v_add_f32 v29, v29, v106
    v_add_f32 v23, v23, v107
    v_add_f32 v28, v28, v108
    v_add_f32 v29, v29, v109
    v_add_f32 v23, v23, v110
    v_add_f32 v28, v28, v111
    v_add_f32 v29, v29, v112
    v_add_f32 v23, v23, v113
    v_add_f32 v28, v28, v114
    v_add_f32 v29, v29, v115
    v_add_f32 v23, v23, v116
    v_add_f32 v28, v28, v117
    v_add_f32 v29, v29, v118
    v_add_f32 v23, v23, v119
    v_add_f32 v28, v28, v120
    v_add_f32 v29, v29, v121
    v_add_f32 v23, v23, v122
    v_add_f32 v28, v28, v123
    v_add_f32 v29, v29, v124
    v_add_f32 v23, v23, v125
    v_add_f32 v28, v28, v126
    v_add_f32 v29, v29, v127
    v_add_f32 v28, v28, v29
    v_add_f32 v23, v23, v28
    v_mov_b32 v26, v23
    s_nop 1
    v_permlane32_swap_b32 v26, v23
    s_nop 1
    v_add_f32 v23, v23, v26
    s_cmp_eq_u32 s20, 1
    s_cbranch_scc1 Lm_38
    ds_write_b64 v6, v[22:23] offset:4096
    s_branch Lm_39
Lm_38:
    ds_write_b64 v7, v[22:23]
    ds_read_b64 v[30:31], v7 offset:4096
Lm_39:
    s_waitcnt vmcnt(14) lgkmcnt(0)
    s_barrier
    s_setprio 1
    s_waitcnt lgkmcnt(5)
    v_mfma_f32_32x32x16_bf16 v[144:159], v[64:67], v[128:131], v[144:159]
    ds_read_b128 v[92:95], v4 offset:7168
    v_mfma_f32_32x32x16_bf16 v[144:159], v[68:71], v[132:135], v[144:159]
    ds_read_b128 v[64:67], v4 offset:8192
    s_waitcnt lgkmcnt(5)
    v_mfma_f32_32x32x16_bf16 v[144:159], v[72:75], v[136:139], v[144:159]
    ds_read_b128 v[68:71], v4 offset:9216
    v_mfma_f32_32x32x16_bf16 v[144:159], v[76:79], v[140:143], v[144:159]
    ds_read_b128 v[72:75], v4 offset:10240
    s_waitcnt lgkmcnt(5)
    v_mfma_f32_32x32x16_bf16 v[160:175], v[80:83], v[128:131], v[160:175]
    ds_read_b128 v[76:79], v4 offset:11264
    v_mfma_f32_32x32x16_bf16 v[160:175], v[84:87], v[132:135], v[160:175]
    ds_read_b128 v[80:83], v4 offset:12288
    s_waitcnt lgkmcnt(5)
    v_mfma_f32_32x32x16_bf16 v[160:175], v[88:91], v[136:139], v[160:175]
    ds_read_b128 v[84:87], v4 offset:13312
    v_mfma_f32_32x32x16_bf16 v[160:175], v[92:95], v[140:143], v[160:175]
    ds_read_b128 v[88:91], v4 offset:14336
    s_waitcnt lgkmcnt(5)
    v_mfma_f32_32x32x16_bf16 v[176:191], v[64:67], v[128:131], v[176:191]
    ds_read_b128 v[92:95], v4 offset:15360
    v_mfma_f32_32x32x16_bf16 v[176:191], v[68:71], v[132:135], v[176:191]
    s_waitcnt lgkmcnt(4)
    v_mfma_f32_32x32x16_bf16 v[176:191], v[72:75], v[136:139], v[176:191]
    v_xor_b32 v4, 0x4000, v4
    v_mfma_f32_32x32x16_bf16 v[176:191], v[76:79], v[140:143], v[176:191]
    s_waitcnt lgkmcnt(2)
    v_mfma_f32_32x32x16_bf16 v[192:207], v[80:83], v[128:131], v[192:207]
    v_mfma_f32_32x32x16_bf16 v[192:207], v[84:87], v[132:135], v[192:207]
    s_waitcnt lgkmcnt(0)
    v_mfma_f32_32x32x16_bf16 v[192:207], v[88:91], v[136:139], v[192:207]
    v_mfma_f32_32x32x16_bf16 v[192:207], v[92:95], v[140:143], v[192:207]
    s_setprio 0
    s_nop 7
    s_nop 7
    s_barrier
    s_cmp_eq_u32 s28, 1
    s_cbranch_scc0 Lnpf
    s_branch Lchk_42
Lpoll_40:
    buffer_load_dword v12, v13, s[4:7], 0 offen sc1
    s_waitcnt vmcnt(0)
Lchk_42:
    v_cmp_eq_u32 vcc, 0, v12
    s_cbranch_vccz Lrdy_41
    s_sleep 2
    s_branch Lpoll_40
Lrdy_41:
    s_add_u32 m0, s62, 0
    s_nop 0
    buffer_load_dwordx4 v15, s[52:55], s61 offen lds
    s_add_u32 m0, s62, 8192
    s_nop 0
    buffer_load_dwordx4 v16, s[52:55], s61 offen lds
    s_add_u32 m0, s62, 16384
    s_nop 0
    buffer_load_dwordx4 v17, s[52:55], s61 offen lds
    buffer_load_dwordx4 v[224:227], v14, s[4:7], s60 offen offset:0 sc1
    buffer_load_dwordx4 v[228:231], v14, s[4:7], s60 offen offset:1024 sc1
    s_add_u32 s61, s61, 81920
    s_add_u32 s60, s60, 4096
    s_add_u32 m0, s62, 65536
    s_nop 0
    buffer_load_dwordx4 v15, s[52:55], s61 offen lds
    s_add_u32 m0, s62, 73728
    s_nop 0
    buffer_load_dwordx4 v16, s[52:55], s61 offen lds
    s_add_u32 m0, s62, 81920
    s_nop 0
    buffer_load_dwordx4 v17, s[52:55], s61 offen lds
    buffer_load_dwordx4 v[232:235], v14, s[4:7], s60 offen offset:0 sc1
    buffer_load_dwordx4 v[236:239], v14, s[4:7], s60 offen offset:1024 sc1
    s_add_u32 s61, s61, 81920
    s_add_u32 s60, s60, 4096
Lnpf:
    s_cmp_eq_u32 s20, 1
    s_cbranch_scc1 Lg1_43
    ds_read_b64 v[30:31], v6
    s_waitcnt lgkmcnt(0)
    v_max_f32 v26, v22, v30
    v_sub_f32 v28, v22, v26
    v_sub_f32 v30, v30, v26
    v_exp_f32 v28, v28
    v_exp_f32 v30, v30
    s_nop 0
    v_mul_f32 v26, v23, v28
    v_fmac_f32 v26, v31, v30
    v_rcp_f32 v26, v26
    s_nop 0
    v_mul_f32 v28, v28, v26
    v_pk_mul_f32 v[176:177], v[176:177], v[28:29] op_sel_hi:[1,0]
    v_pk_mul_f32 v[178:179], v[178:179], v[28:29] op_sel_hi:[1,0]
    v_pk_mul_f32 v[180:181], v[180:181], v[28:29] op_sel_hi:[1,0]
    v_pk_mul_f32 v[182:183], v[182:183], v[28:29] op_sel_hi:[1,0]
    v_pk_mul_f32 v[184:185], v[184:185], v[28:29] op_sel_hi:[1,0]
    v_pk_mul_f32 v[186:187], v[186:187], v[28:29] op_sel_hi:[1,0]
    v_pk_mul_f32 v[188:189], v[188:189], v[28:29] op_sel_hi:[1,0]
    v_pk_mul_f32 v[190:191], v[190:191], v[28:29] op_sel_hi:[1,0]
    v_pk_mul_f32 v[192:193], v[192:193], v[28:29] op_sel_hi:[1,0]
    v_pk_mul_f32 v[194:195], v[194:195], v[28:29] op_sel_hi:[1,0]
    v_pk_mul_f32 v[196:197], v[196:197], v[28:29] op_sel_hi:[1,0]
    v_pk_mul_f32 v[198:199], v[198:199], v[28:29] op_sel_hi:[1,0]
    v_pk_mul_f32 v[200:201], v[200:201], v[28:29] op_sel_hi:[1,0]
    v_pk_mul_f32 v[202:203], v[202:203], v[28:29] op_sel_hi:[1,0]
    v_pk_mul_f32 v[204:205], v[204:205], v[28:29] op_sel_hi:[1,0]
    v_pk_mul_f32 v[206:207], v[206:207], v[28:29] op_sel_hi:[1,0]
    ds_write_b128 v6, v[176:179] offset:0
    ds_write_b128 v6, v[180:183] offset:1024
    ds_write_b128 v6, v[184:187] offset:2048
    ds_write_b128 v6, v[188:191] offset:3072
    ds_write_b128 v6, v[192:195] offset:4096
    ds_write_b128 v6, v[196:199] offset:5120
    ds_write_b128 v6, v[200:203] offset:6144
    ds_write_b128 v6, v[204:207] offset:7168
    s_waitcnt lgkmcnt(0)
    s_barrier
    s_barrier
    ds_read_b128 v[96:99], v7 offset:0
    ds_read_b128 v[100:103], v7 offset:1024
    ds_read_b128 v[104:107], v7 offset:2048
    ds_read_b128 v[108:111], v7 offset:3072
    ds_read_b128 v[112:115], v7 offset:4096
    ds_read_b128 v[116:119], v7 offset:5120
    ds_read_b128 v[120:123], v7 offset:6144
    ds_read_b128 v[124:127], v7 offset:7168
    s_waitcnt lgkmcnt(6)
    v_fma_f32 v144, v144, v28, v96
    v_fma_f32 v145, v145, v28, v97
    v_fma_f32 v146, v146, v28, v98
    v_fma_f32 v147, v147, v28, v99
    v_fma_f32 v148, v148, v28, v100
    v_fma_f32 v149, v149, v28, v101
    v_fma_f32 v150, v150, v28, v102
    v_fma_f32 v151, v151, v28, v103
    v_cvt_pk_bf16_f32 v208, v144, v145
    v_cvt_pk_bf16_f32 v209, v146, v147
    v_cvt_pk_bf16_f32 v210, v148, v149
    v_cvt_pk_bf16_f32 v211, v150, v151
    s_cmp_eq_u32 s28, 1
    s_cbranch_scc0 1f
    s_waitcnt vmcnt(10)
    1:
    buffer_store_dwordx4 v[208:211], v5, s[4:7], s29 offen offset:0 sc1
    s_waitcnt lgkmcnt(4)
    v_fma_f32 v152, v152, v28, v104
    v_fma_f32 v153, v153, v28, v105
    v_fma_f32 v154, v154, v28, v106
    v_fma_f32 v155, v155, v28, v107
    v_fma_f32 v156, v156, v28, v108
    v_fma_f32 v157, v157, v28, v109
    v_fma_f32 v158, v158, v28, v110
    v_fma_f32 v159, v159, v28, v111
    v_cvt_pk_bf16_f32 v212, v152, v153
    v_cvt_pk_bf16_f32 v213, v154, v155
    v_cvt_pk_bf16_f32 v214, v156, v157
    v_cvt_pk_bf16_f32 v215, v158, v159
    buffer_store_dwordx4 v[212:215], v5, s[4:7], s29 offen offset:1024 sc1
    s_waitcnt lgkmcnt(2)
    v_fma_f32 v160, v160, v28, v112
    v_fma_f32 v161, v161, v28, v113
    v_fma_f32 v162, v162, v28, v114
    v_fma_f32 v163, v163, v28, v115
    v_fma_f32 v164, v164, v28, v116
    v_fma_f32 v165, v165, v28, v117
    v_fma_f32 v166, v166, v28, v118
    v_fma_f32 v167, v167, v28, v119
    v_cvt_pk_bf16_f32 v216, v160, v161
    v_cvt_pk_bf16_f32 v217, v162, v163
    v_cvt_pk_bf16_f32 v218, v164, v165
    v_cvt_pk_bf16_f32 v219, v166, v167
    buffer_store_dwordx4 v[216:219], v5, s[4:7], s29 offen offset:2048 sc1
    s_waitcnt lgkmcnt(0)
    v_fma_f32 v168, v168, v28, v120
    v_fma_f32 v169, v169, v28, v121
    v_fma_f32 v170, v170, v28, v122
    v_fma_f32 v171, v171, v28, v123
    v_fma_f32 v172, v172, v28, v124
    v_fma_f32 v173, v173, v28, v125
    v_fma_f32 v174, v174, v28, v126
    v_fma_f32 v175, v175, v28, v127
    v_cvt_pk_bf16_f32 v220, v168, v169
    v_cvt_pk_bf16_f32 v221, v170, v171
    v_cvt_pk_bf16_f32 v222, v172, v173
    v_cvt_pk_bf16_f32 v223, v174, v175
    buffer_store_dwordx4 v[220:223], v5, s[4:7], s29 offen offset:3072 sc1
    s_branch Lgj_44
Lg1_43:
    v_max_f32 v26, v22, v30
    v_sub_f32 v28, v22, v26
    v_sub_f32 v30, v30, v26
    v_exp_f32 v28, v28
    v_exp_f32 v30, v30
    s_nop 0
    v_mul_f32 v26, v23, v28
    v_fmac_f32 v26, v31, v30
    v_rcp_f32 v26, v26
    s_nop 0
    v_mul_f32 v28, v28, v26
    v_pk_mul_f32 v[144:145], v[144:145], v[28:29] op_sel_hi:[1,0]
    v_pk_mul_f32 v[146:147], v[146:147], v[28:29] op_sel_hi:[1,0]
    v_pk_mul_f32 v[148:149], v[148:149], v[28:29] op_sel_hi:[1,0]
    v_pk_mul_f32 v[150:151], v[150:151], v[28:29] op_sel_hi:[1,0]
    v_pk_mul_f32 v[152:153], v[152:153], v[28:29] op_sel_hi:[1,0]
    v_pk_mul_f32 v[154:155], v[154:155], v[28:29] op_sel_hi:[1,0]
    v_pk_mul_f32 v[156:157], v[156:157], v[28:29] op_sel_hi:[1,0]
    v_pk_mul_f32 v[158:159], v[158:159], v[28:29] op_sel_hi:[1,0]
    v_pk_mul_f32 v[160:161], v[160:161], v[28:29] op_sel_hi:[1,0]
    v_pk_mul_f32 v[162:163], v[162:163], v[28:29] op_sel_hi:[1,0]
    v_pk_mul_f32 v[164:165], v[164:165], v[28:29] op_sel_hi:[1,0]
    v_pk_mul_f32 v[166:167], v[166:167], v[28:29] op_sel_hi:[1,0]
    v_pk_mul_f32 v[168:169], v[168:169], v[28:29] op_sel_hi:[1,0]
    v_pk_mul_f32 v[170:171], v[170:171], v[28:29] op_sel_hi:[1,0]
    v_pk_mul_f32 v[172:173], v[172:173], v[28:29] op_sel_hi:[1,0]
    v_pk_mul_f32 v[174:175], v[174:175], v[28:29] op_sel_hi:[1,0]
    ds_write_b128 v6, v[144:147] offset:0
    ds_write_b128 v6, v[148:151] offset:1024
    ds_write_b128 v6, v[152:155] offset:2048
    ds_write_b128 v6, v[156:159] offset:3072
    ds_write_b128 v6, v[160:163] offset:4096
    ds_write_b128 v6, v[164:167] offset:5120
    ds_write_b128 v6, v[168:171] offset:6144
    ds_write_b128 v6, v[172:175] offset:7168
    s_waitcnt lgkmcnt(0)
    s_barrier
    ds_read_b128 v[96:99], v7 offset:0
    ds_read_b128 v[100:103], v7 offset:1024
    ds_read_b128 v[104:107], v7 offset:2048
    ds_read_b128 v[108:111], v7 offset:3072
    ds_read_b128 v[112:115], v7 offset:4096
    ds_read_b128 v[116:119], v7 offset:5120
    ds_read_b128 v[120:123], v7 offset:6144
    ds_read_b128 v[124:127], v7 offset:7168
    s_waitcnt lgkmcnt(6)
    v_fma_f32 v176, v176, v28, v96
    v_fma_f32 v177, v177, v28, v97
    v_fma_f32 v178, v178, v28, v98
    v_fma_f32 v179, v179, v28, v99
    v_fma_f32 v180, v180, v28, v100
    v_fma_f32 v181, v181, v28, v101
    v_fma_f32 v182, v182, v28, v102
    v_fma_f32 v183, v183, v28, v103
    v_cvt_pk_bf16_f32 v208, v176, v177
    v_cvt_pk_bf16_f32 v209, v178, v179
    v_cvt_pk_bf16_f32 v210, v180, v181
    v_cvt_pk_bf16_f32 v211, v182, v183
    s_cmp_eq_u32 s28, 1
    s_cbranch_scc0 1f
    s_waitcnt vmcnt(10)
    1:
    buffer_store_dwordx4 v[208:211], v5, s[4:7], s29 offen offset:0 sc1
    s_waitcnt lgkmcnt(4)
    v_fma_f32 v184, v184, v28, v104
    v_fma_f32 v185, v185, v28, v105
    v_fma_f32 v186, v186, v28, v106
    v_fma_f32 v187, v187, v28, v107
    v_fma_f32 v188, v188, v28, v108
    v_fma_f32 v189, v189, v28, v109
    v_fma_f32 v190, v190, v28, v110
    v_fma_f32 v191, v191, v28, v111
    v_cvt_pk_bf16_f32 v212, v184, v185
    v_cvt_pk_bf16_f32 v213, v186, v187
    v_cvt_pk_bf16_f32 v214, v188, v189
    v_cvt_pk_bf16_f32 v215, v190, v191
    buffer_store_dwordx4 v[212:215], v5, s[4:7], s29 offen offset:1024 sc1
    s_waitcnt lgkmcnt(2)
    v_fma_f32 v192, v192, v28, v112
    v_fma_f32 v193, v193, v28, v113
    v_fma_f32 v194, v194, v28, v114
    v_fma_f32 v195, v195, v28, v115
    v_fma_f32 v196, v196, v28, v116
    v_fma_f32 v197, v197, v28, v117
    v_fma_f32 v198, v198, v28, v118
    v_fma_f32 v199, v199, v28, v119
    v_cvt_pk_bf16_f32 v216, v192, v193
    v_cvt_pk_bf16_f32 v217, v194, v195
    v_cvt_pk_bf16_f32 v218, v196, v197
    v_cvt_pk_bf16_f32 v219, v198, v199
    buffer_store_dwordx4 v[216:219], v5, s[4:7], s29 offen offset:2048 sc1
    s_waitcnt lgkmcnt(0)
    v_fma_f32 v200, v200, v28, v120
    v_fma_f32 v201, v201, v28, v121
    v_fma_f32 v202, v202, v28, v122
    v_fma_f32 v203, v203, v28, v123
    v_fma_f32 v204, v204, v28, v124
    v_fma_f32 v205, v205, v28, v125
    v_fma_f32 v206, v206, v28, v126
    v_fma_f32 v207, v207, v28, v127
    v_cvt_pk_bf16_f32 v220, v200, v201
    v_cvt_pk_bf16_f32 v221, v202, v203
    v_cvt_pk_bf16_f32 v222, v204, v205
    v_cvt_pk_bf16_f32 v223, v206, v207
    buffer_store_dwordx4 v[220:223], v5, s[4:7], s29 offen offset:3072 sc1
Lgj_44:
    s_mov_b32 s19, s35
    s_add_u32 s28, s28, 1
    s_cmp_lt_u32 s28, 2
    s_cbranch_scc1 Lblk_25
    s_barrier
    s_add_u32 m0, s62, 32768
    s_nop 0
    buffer_load_dwordx4 v15, s[52:55], s61 offen lds
    s_add_u32 m0, s62, 40960
    s_nop 0
    buffer_load_dwordx4 v16, s[52:55], s61 offen lds
    s_add_u32 m0, s62, 49152
    s_nop 0
    buffer_load_dwordx4 v17, s[52:55], s61 offen lds
    buffer_load_dwordx4 v[208:211], v14, s[4:7], s60 offen offset:0 sc1
    buffer_load_dwordx4 v[212:215], v14, s[4:7], s60 offen offset:1024 sc1
    s_add_u32 s61, s61, 81920
    s_add_u32 s60, s60, 4096
    s_add_u32 m0, s62, 98304
    s_nop 0
    buffer_load_dwordx4 v15, s[52:55], s61 offen lds
    s_add_u32 m0, s62, 106496
    s_nop 0
    buffer_load_dwordx4 v16, s[52:55], s61 offen lds
    s_add_u32 m0, s62, 114688
    s_nop 0
    buffer_load_dwordx4 v17, s[52:55], s61 offen lds
    buffer_load_dwordx4 v[216:219], v14, s[4:7], s60 offen offset:0 sc1
    buffer_load_dwordx4 v[220:223], v14, s[4:7], s60 offen offset:1024 sc1
    s_add_u32 s61, s61, 81920
    s_add_u32 s60, s60, 4096
    s_load_dwordx2 s[40:41], s[0:1], 40
    s_load_dwordx2 s[44:45], s[0:1], 72
    s_load_dwordx2 s[48:49], s[0:1], 0
    s_load_dwordx4 s[52:55], s[0:1], 80
    s_load_dwordx2 s[56:57], s[0:1], 96
    s_bfe_u32 s38, s2, 0x20004
    s_and_b32 s37, s2, 7
    s_lshl_b32 s37, s37, 1
    s_bfe_u32 s3, s2, 0x10003
    s_add_u32 s37, s37, s3
    s_lshr_b32 s36, s2, 6
    s_and_b32 s34, s21, 3
    s_lshr_b32 s35, s21, 2
    v_lshlrev_b32 v10, 4, v1
    s_mov_b32 s18, s60
    s_mov_b32 s19, s61
    s_mov_b32 s23, s62
    v_lshrrev_b32 v176, 5, v1
    v_lshlrev_b32 v176, 2, v176
    v_bfe_u32 v177, v1, 2, 2
    v_add_u32 v176, v176, v177
    v_mul_u32_u24 v176, 0x140, v176
    v_bfe_u32 v177, v1, 4, 1
    v_lshl_add_u32 v176, v177, 5, v176
    v_and_b32 v177, 3, v1
    v_lshl_add_u32 v176, v177, 3, v176
    s_mul_i32 s30, s35, 10240
    v_add_u32 v7, s30, v176
    v_mov_b32 v9, v7
    v_mov_b32 v11, 0
    v_mov_b32 v64, 0
    v_mov_b32 v65, 0
    v_mov_b32 v66, 0
    v_mov_b32 v67, 0
    v_mov_b32 v68, 0
    v_mov_b32 v69, 0
    v_mov_b32 v70, 0
    v_mov_b32 v71, 0
    v_mov_b32 v72, 0
    v_mov_b32 v73, 0
    v_mov_b32 v74, 0
    v_mov_b32 v75, 0
    v_mov_b32 v76, 0
    v_mov_b32 v77, 0
    v_mov_b32 v78, 0
    v_mov_b32 v79, 0
    v_mov_b32 v80, 0
    v_mov_b32 v81, 0
    v_mov_b32 v82, 0
    v_mov_b32 v83, 0
    v_mov_b32 v84, 0
    v_mov_b32 v85, 0
    v_mov_b32 v86, 0
    v_mov_b32 v87, 0
    v_mov_b32 v88, 0
    v_mov_b32 v89, 0
    v_mov_b32 v90, 0
    v_mov_b32 v91, 0
    v_mov_b32 v92, 0
    v_mov_b32 v93, 0
    v_mov_b32 v94, 0
    v_mov_b32 v95, 0
    v_mov_b32 v96, 0
    v_mov_b32 v97, 0
    v_mov_b32 v98, 0
    v_mov_b32 v99, 0
    v_mov_b32 v100, 0
    v_mov_b32 v101, 0
    v_mov_b32 v102, 0
    v_mov_b32 v103, 0
    v_mov_b32 v104, 0
    v_mov_b32 v105, 0
    v_mov_b32 v106, 0
    v_mov_b32 v107, 0
    v_mov_b32 v108, 0
    v_mov_b32 v109, 0
    v_mov_b32 v110, 0
    v_mov_b32 v111, 0
    v_mov_b32 v112, 0
    v_mov_b32 v113, 0
    v_mov_b32 v114, 0
    v_mov_b32 v115, 0
    v_mov_b32 v116, 0
    v_mov_b32 v117, 0
    v_mov_b32 v118, 0
    v_mov_b32 v119, 0
    v_mov_b32 v120, 0
    v_mov_b32 v121, 0
    v_mov_b32 v122, 0
    v_mov_b32 v123, 0
    v_mov_b32 v124, 0
    v_mov_b32 v125, 0
    v_mov_b32 v126, 0
    v_mov_b32 v127, 0
    v_mov_b32 v128, 0
    v_mov_b32 v129, 0
    v_mov_b32 v130, 0
    v_mov_b32 v131, 0
    v_mov_b32 v132, 0
    v_mov_b32 v133, 0
    v_mov_b32 v134, 0
    v_mov_b32 v135, 0
    v_mov_b32 v136, 0
    v_mov_b32 v137, 0
    v_mov_b32 v138, 0
    v_mov_b32 v139, 0
    v_mov_b32 v140, 0
    v_mov_b32 v141, 0
    v_mov_b32 v142, 0
    v_mov_b32 v143, 0
    s_waitcnt lgkmcnt(0)
    s_mov_b32 s4, s56
    s_and_b32 s5, s57, 0xffff
    s_mov_b32 s6, 268435456
    s_mov_b32 s7, 0x00020000
    s_mov_b32 s12, s56
    s_and_b32 s13, s57, 0xffff
    s_mov_b32 s14, 268435456
    s_mov_b32 s15, 0x00020000
    s_mov_b32 s8, s44
    s_and_b32 s9, s45, 0xffff
    s_mov_b32 s10, 2211840
    s_mov_b32 s11, 0x00020000
    s_and_b32 s41, s41, 0xffff
    s_lshr_b32 s30, s2, 5
    s_sub_u32 s31, 15, s30
    v_mov_b32 v176, s30
    v_mov_b32 v177, s31
    v_cmp_eq_u32 vcc, 0, v1
    v_cndmask_b32 v176, v176, v177, vcc
    v_lshlrev_b32 v176, 10, v176
    s_bfe_u32 s30, s2, 0x10002
    s_lshl_b32 s30, s30, 8
    s_and_b32 s31, s2, 16
    s_lshl_b32 s31, s31, 5
    s_add_u32 s30, s30, s31
    s_and_b32 s31, s2, 3
    s_lshl_b32 s31, s31, 3
    s_add_u32 s30, s30, s31
    s_bfe_u32 s31, s2, 0x10003
    s_lshl_b32 s31, s31, 2
    s_add_u32 s30, s30, s31
    s_add_u32 s30, s30, 117702656
    v_mov_b32 v177, 1
    s_waitcnt vmcnt(19)
    s_barrier
    ds_read_b64_tr_b16 v[20:21], v9 offset:0
    ds_read_b64_tr_b16 v[22:23], v9 offset:2560
    ds_read_b64_tr_b16 v[24:25], v9 offset:64
    ds_read_b64_tr_b16 v[26:27], v9 offset:2624
    ds_read_b64_tr_b16 v[28:29], v9 offset:128
    ds_read_b64_tr_b16 v[30:31], v9 offset:2688
    ds_read_b64_tr_b16 v[32:33], v9 offset:192
    ds_read_b64_tr_b16 v[34:35], v9 offset:2752
    ds_read_b64_tr_b16 v[36:37], v9 offset:256
    ds_read_b64_tr_b16 v[38:39], v9 offset:2816
    s_lshl_b32 s33, s37, 2
    s_add_u32 s33, s33, s38
    s_lshl_b32 s33, s33, 8
    s_add_u32 s33, s33, 117702656
    v_and_b32 v11, 7, v1
    v_lshlrev_b32 v11, 2, v11
    s_waitcnt lgkmcnt(0)
    v_mfma_f32_32x32x16_bf16 v[64:79], v[20:23], v[224:227], v[64:79]
    ds_read_b64_tr_b16 v[40:41], v9 offset:5120
    ds_read_b64_tr_b16 v[42:43], v9 offset:7680
    v_mfma_f32_32x32x16_bf16 v[80:95], v[24:27], v[224:227], v[80:95]
    ds_read_b64_tr_b16 v[44:45], v9 offset:5184
    ds_read_b64_tr_b16 v[46:47], v9 offset:7744
    v_mfma_f32_32x32x16_bf16 v[96:111], v[28:31], v[224:227], v[96:111]
    ds_read_b64_tr_b16 v[48:49], v9 offset:5248
    ds_read_b64_tr_b16 v[50:51], v9 offset:7808
    v_mfma_f32_32x32x16_bf16 v[112:127], v[32:35], v[224:227], v[112:127]
    ds_read_b64_tr_b16 v[52:53], v9 offset:5312
    ds_read_b64_tr_b16 v[54:55], v9 offset:7872
    v_mfma_f32_32x32x16_bf16 v[128:143], v[36:39], v[224:227], v[128:143]
    ds_read_b64_tr_b16 v[56:57], v9 offset:5376
    ds_read_b64_tr_b16 v[58:59], v9 offset:7936
    s_nop 0
    s_waitcnt vmcnt(14) lgkmcnt(0)
    s_barrier
    v_add_u32 v9, 65536, v7
    v_mfma_f32_32x32x16_bf16 v[64:79], v[40:43], v[228:231], v[64:79]
    ds_read_b64_tr_b16 v[20:21], v9 offset:0
    ds_read_b64_tr_b16 v[22:23], v9 offset:2560
    ds_read_b64_tr_b16 v[24:25], v9 offset:64
    ds_read_b64_tr_b16 v[26:27], v9 offset:2624
    v_mfma_f32_32x32x16_bf16 v[80:95], v[44:47], v[228:231], v[80:95]
    ds_read_b64_tr_b16 v[28:29], v9 offset:128
    ds_read_b64_tr_b16 v[30:31], v9 offset:2688
    ds_read_b64_tr_b16 v[32:33], v9 offset:192
    ds_read_b64_tr_b16 v[34:35], v9 offset:2752
    v_mfma_f32_32x32x16_bf16 v[96:111], v[48:51], v[228:231], v[96:111]
    ds_read_b64_tr_b16 v[36:37], v9 offset:256
    ds_read_b64_tr_b16 v[38:39], v9 offset:2816
    s_add_u32 m0, s23, 0
    s_nop 0
    buffer_load_dwordx4 v15, s[8:11], s19 offen lds
    v_mfma_f32_32x32x16_bf16 v[112:127], v[52:55], v[228:231], v[112:127]
    s_add_u32 m0, s23, 8192
    s_nop 0
    buffer_load_dwordx4 v16, s[8:11], s19 offen lds
    s_add_u32 m0, s23, 16384
    s_nop 0
    buffer_load_dwordx4 v17, s[8:11], s19 offen lds
    v_mfma_f32_32x32x16_bf16 v[128:143], v[56:59], v[228:231], v[128:143]
    buffer_load_dwordx4 v[224:227], v14, s[4:7], s18 offen offset:0 sc1
    buffer_load_dwordx4 v[228:231], v14, s[4:7], s18 offen offset:1024 sc1
    s_add_u32 s19, s19, 81920
    s_add_u32 s18, s18, 4096
    s_waitcnt lgkmcnt(0)
    v_mfma_f32_32x32x16_bf16 v[64:79], v[20:23], v[232:235], v[64:79]
    ds_read_b64_tr_b16 v[40:41], v9 offset:5120
    ds_read_b64_tr_b16 v[42:43], v9 offset:7680
    v_mfma_f32_32x32x16_bf16 v[80:95], v[24:27], v[232:235], v[80:95]
    ds_read_b64_tr_b16 v[44:45], v9 offset:5184
    ds_read_b64_tr_b16 v[46:47], v9 offset:7744
    v_mfma_f32_32x32x16_bf16 v[96:111], v[28:31], v[232:235], v[96:111]
    ds_read_b64_tr_b16 v[48:49], v9 offset:5248
    ds_read_b64_tr_b16 v[50:51], v9 offset:7808
    v_mfma_f32_32x32x16_bf16 v[112:127], v[32:35], v[232:235], v[112:127]
    ds_read_b64_tr_b16 v[52:53], v9 offset:5312
    ds_read_b64_tr_b16 v[54:55], v9 offset:7872
    v_mfma_f32_32x32x16_bf16 v[128:143], v[36:39], v[232:235], v[128:143]
    ds_read_b64_tr_b16 v[56:57], v9 offset:5376
    ds_read_b64_tr_b16 v[58:59], v9 offset:7936
    s_nop 0
    s_waitcnt vmcnt(10) lgkmcnt(0)
    s_barrier
    v_add_u32 v9, 32768, v7
    v_mfma_f32_32x32x16_bf16 v[64:79], v[40:43], v[236:239], v[64:79]
    ds_read_b64_tr_b16 v[20:21], v9 offset:0
    ds_read_b64_tr_b16 v[22:23], v9 offset:2560
    ds_read_b64_tr_b16 v[24:25], v9 offset:64
    ds_read_b64_tr_b16 v[26:27], v9 offset:2624
    v_mfma_f32_32x32x16_bf16 v[80:95], v[44:47], v[236:239], v[80:95]
    ds_read_b64_tr_b16 v[28:29], v9 offset:128
    ds_read_b64_tr_b16 v[30:31], v9 offset:2688
    ds_read_b64_tr_b16 v[32:33], v9 offset:192
    ds_read_b64_tr_b16 v[34:35], v9 offset:2752
    v_mfma_f32_32x32x16_bf16 v[96:111], v[48:51], v[236:239], v[96:111]
    ds_read_b64_tr_b16 v[36:37], v9 offset:256
    ds_read_b64_tr_b16 v[38:39], v9 offset:2816
    s_cmp_eq_u32 s21, 0
    s_cbranch_scc0 1f
    s_mov_b64 exec, 3
    buffer_store_dword v177, v176, s[12:15], s30 offen sc1
    s_mov_b64 exec, -1
    1:
    s_add_u32 m0, s23, 65536
    s_nop 0
    buffer_load_dwordx4 v15, s[8:11], s19 offen lds
    v_mfma_f32_32x32x16_bf16 v[112:127], v[52:55], v[236:239], v[112:127]
    s_add_u32 m0, s23, 73728
    s_nop 0
    buffer_load_dwordx4 v16, s[8:11], s19 offen lds
    s_add_u32 m0, s23, 81920
    s_nop 0
    buffer_load_dwordx4 v17, s[8:11], s19 offen lds
    v_mfma_f32_32x32x16_bf16 v[128:143], v[56:59], v[236:239], v[128:143]
    buffer_load_dwordx4 v[232:235], v14, s[4:7], s18 offen offset:0 sc1
    buffer_load_dwordx4 v[236:239], v14, s[4:7], s18 offen offset:1024 sc1
    s_add_u32 s19, s19, 81920
    s_add_u32 s18, s18, 4096
    s_waitcnt lgkmcnt(0)
    v_mfma_f32_32x32x16_bf16 v[64:79], v[20:23], v[208:211], v[64:79]
    ds_read_b64_tr_b16 v[40:41], v9 offset:5120
    ds_read_b64_tr_b16 v[42:43], v9 offset:7680
    v_mfma_f32_32x32x16_bf16 v[80:95], v[24:27], v[208:211], v[80:95]
    ds_read_b64_tr_b16 v[44:45], v9 offset:5184
    ds_read_b64_tr_b16 v[46:47], v9 offset:7744
    v_mfma_f32_32x32x16_bf16 v[96:111], v[28:31], v[208:211], v[96:111]
    ds_read_b64_tr_b16 v[48:49], v9 offset:5248
    ds_read_b64_tr_b16 v[50:51], v9 offset:7808
    v_mfma_f32_32x32x16_bf16 v[112:127], v[32:35], v[208:211], v[112:127]
    ds_read_b64_tr_b16 v[52:53], v9 offset:5312
    ds_read_b64_tr_b16 v[54:55], v9 offset:7872
    v_mfma_f32_32x32x16_bf16 v[128:143], v[36:39], v[208:211], v[128:143]
    ds_read_b64_tr_b16 v[56:57], v9 offset:5376
    ds_read_b64_tr_b16 v[58:59], v9 offset:7936
    s_cmp_eq_u32 s38, 3
    s_cselect_b32 s6, 0, s6
    s_waitcnt vmcnt(10) lgkmcnt(0)
    s_barrier
    v_add_u32 v9, 98304, v7
    v_mfma_f32_32x32x16_bf16 v[64:79], v[40:43], v[212:215], v[64:79]
    ds_read_b64_tr_b16 v[20:21], v9 offset:0
    ds_read_b64_tr_b16 v[22:23], v9 offset:2560
    ds_read_b64_tr_b16 v[24:25], v9 offset:64
    ds_read_b64_tr_b16 v[26:27], v9 offset:2624
    v_mfma_f32_32x32x16_bf16 v[80:95], v[44:47], v[212:215], v[80:95]
    ds_read_b64_tr_b16 v[28:29], v9 offset:128
    ds_read_b64_tr_b16 v[30:31], v9 offset:2688
    ds_read_b64_tr_b16 v[32:33], v9 offset:192
    ds_read_b64_tr_b16 v[34:35], v9 offset:2752
    v_mfma_f32_32x32x16_bf16 v[96:111], v[48:51], v[212:215], v[96:111]
    ds_read_b64_tr_b16 v[36:37], v9 offset:256
    ds_read_b64_tr_b16 v[38:39], v9 offset:2816
    s_add_u32 m0, s23, 32768
    s_nop 0
    buffer_load_dwordx4 v15, s[8:11], s19 offen lds
    v_mfma_f32_32x32x16_bf16 v[112:127], v[52:55], v[212:215], v[112:127]
    s_add_u32 m0, s23, 40960
    s_nop 0
    buffer_load_dwordx4 v16, s[8:11], s19 offen lds
    s_add_u32 m0, s23, 49152
    s_nop 0
    buffer_load_dwordx4 v17, s[8:11], s19 offen lds
    v_mfma_f32_32x32x16_bf16 v[128:143], v[56:59], v[212:215], v[128:143]
    buffer_load_dwordx4 v[208:211], v14, s[4:7], s18 offen offset:0 sc1
    buffer_load_dwordx4 v[212:215], v14, s[4:7], s18 offen offset:1024 sc1
    s_add_u32 s19, s19, 81920
    s_add_u32 s18, s18, 4096
    s_waitcnt lgkmcnt(0)
    v_mfma_f32_32x32x16_bf16 v[64:79], v[20:23], v[216:219], v[64:79]
    ds_read_b64_tr_b16 v[40:41], v9 offset:5120
    ds_read_b64_tr_b16 v[42:43], v9 offset:7680
    v_mfma_f32_32x32x16_bf16 v[80:95], v[24:27], v[216:219], v[80:95]
    ds_read_b64_tr_b16 v[44:45], v9 offset:5184
    ds_read_b64_tr_b16 v[46:47], v9 offset:7744
    v_mfma_f32_32x32x16_bf16 v[96:111], v[28:31], v[216:219], v[96:111]
    ds_read_b64_tr_b16 v[48:49], v9 offset:5248
    ds_read_b64_tr_b16 v[50:51], v9 offset:7808
    v_mfma_f32_32x32x16_bf16 v[112:127], v[32:35], v[216:219], v[112:127]
    ds_read_b64_tr_b16 v[52:53], v9 offset:5312
    ds_read_b64_tr_b16 v[54:55], v9 offset:7872
    v_mfma_f32_32x32x16_bf16 v[128:143], v[36:39], v[216:219], v[128:143]
    ds_read_b64_tr_b16 v[56:57], v9 offset:5376
    ds_read_b64_tr_b16 v[58:59], v9 offset:7936
    s_mov_b32 s6, 0
    s_mov_b32 s8, s40
    s_mov_b32 s9, s41
    s_mov_b32 s10, 5242880
    s_mul_i32 s19, s38, 1310720
    s_waitcnt vmcnt(10) lgkmcnt(0)
    s_barrier
    v_add_u32 v9, 0, v7
    v_mfma_f32_32x32x16_bf16 v[64:79], v[40:43], v[220:223], v[64:79]
    ds_read_b64_tr_b16 v[20:21], v9 offset:0
    ds_read_b64_tr_b16 v[22:23], v9 offset:2560
    ds_read_b64_tr_b16 v[24:25], v9 offset:64
    ds_read_b64_tr_b16 v[26:27], v9 offset:2624
    v_mfma_f32_32x32x16_bf16 v[80:95], v[44:47], v[220:223], v[80:95]
    ds_read_b64_tr_b16 v[28:29], v9 offset:128
    ds_read_b64_tr_b16 v[30:31], v9 offset:2688
    ds_read_b64_tr_b16 v[32:33], v9 offset:192
    ds_read_b64_tr_b16 v[34:35], v9 offset:2752
    v_mfma_f32_32x32x16_bf16 v[96:111], v[48:51], v[220:223], v[96:111]
    ds_read_b64_tr_b16 v[36:37], v9 offset:256
    ds_read_b64_tr_b16 v[38:39], v9 offset:2816
    buffer_load_dword v179, v11, s[12:15], s33 offen sc1
    s_add_u32 m0, s23, 98304
    s_nop 0
    buffer_load_dwordx4 v15, s[8:11], s19 offen lds
    v_mfma_f32_32x32x16_bf16 v[112:127], v[52:55], v[220:223], v[112:127]
    s_add_u32 m0, s23, 106496
    s_nop 0
    buffer_load_dwordx4 v16, s[8:11], s19 offen lds
    s_add_u32 m0, s23, 114688
    s_nop 0
    buffer_load_dwordx4 v17, s[8:11], s19 offen lds
    v_mfma_f32_32x32x16_bf16 v[128:143], v[56:59], v[220:223], v[128:143]
    buffer_load_dwordx4 v[216:219], v14, s[4:7], s18 offen offset:0 sc1
    buffer_load_dwordx4 v[220:223], v14, s[4:7], s18 offen offset:1024 sc1
    s_add_u32 s19, s19, 81920
    s_add_u32 s18, s18, 4096
    s_waitcnt lgkmcnt(0)
    v_mfma_f32_32x32x16_bf16 v[64:79], v[20:23], v[224:227], v[64:79]
    ds_read_b64_tr_b16 v[40:41], v9 offset:5120
    ds_read_b64_tr_b16 v[42:43], v9 offset:7680
    v_mfma_f32_32x32x16_bf16 v[80:95], v[24:27], v[224:227], v[80:95]
    ds_read_b64_tr_b16 v[44:45], v9 offset:5184
    ds_read_b64_tr_b16 v[46:47], v9 offset:7744
    v_mfma_f32_32x32x16_bf16 v[96:111], v[28:31], v[224:227], v[96:111]
    ds_read_b64_tr_b16 v[48:49], v9 offset:5248
    ds_read_b64_tr_b16 v[50:51], v9 offset:7808
    v_mfma_f32_32x32x16_bf16 v[112:127], v[32:35], v[224:227], v[112:127]
    ds_read_b64_tr_b16 v[52:53], v9 offset:5312
    ds_read_b64_tr_b16 v[54:55], v9 offset:7872
    v_mfma_f32_32x32x16_bf16 v[128:143], v[36:39], v[224:227], v[128:143]
    ds_read_b64_tr_b16 v[56:57], v9 offset:5376
    ds_read_b64_tr_b16 v[58:59], v9 offset:7936
    s_nop 0
    s_waitcnt vmcnt(5)
    v_cmp_eq_u32 vcc, 0, v179
    s_cbranch_vccz Lok_45
Lpoll_46:
    buffer_load_dword v179, v11, s[12:15], s33 offen sc1
    s_waitcnt vmcnt(0)
    v_cmp_eq_u32 vcc, 0, v179
    s_cbranch_vccz Lrdy_47
    s_sleep 4
    s_branch Lpoll_46
Lrdy_47:
Lok_45:
    s_mov_b32 s6, 268435456
    s_lshl_b32 s18, s38, 16
    buffer_load_dwordx4 v[216:219], v14, s[4:7], s18 offen offset:0 sc1
    buffer_load_dwordx4 v[220:223], v14, s[4:7], s18 offen offset:1024 sc1
    s_add_u32 s18, s18, 4096
    s_waitcnt vmcnt(10) lgkmcnt(0)
    s_barrier
    v_add_u32 v9, 65536, v7
    v_mfma_f32_32x32x16_bf16 v[64:79], v[40:43], v[228:231], v[64:79]
    ds_read_b64_tr_b16 v[20:21], v9 offset:0
    ds_read_b64_tr_b16 v[22:23], v9 offset:2560
    ds_read_b64_tr_b16 v[24:25], v9 offset:64
    ds_read_b64_tr_b16 v[26:27], v9 offset:2624
    v_mfma_f32_32x32x16_bf16 v[80:95], v[44:47], v[228:231], v[80:95]
    ds_read_b64_tr_b16 v[28:29], v9 offset:128
    ds_read_b64_tr_b16 v[30:31], v9 offset:2688
    ds_read_b64_tr_b16 v[32:33], v9 offset:192
    ds_read_b64_tr_b16 v[34:35], v9 offset:2752
    v_mfma_f32_32x32x16_bf16 v[96:111], v[48:51], v[228:231], v[96:111]
    ds_read_b64_tr_b16 v[36:37], v9 offset:256
    ds_read_b64_tr_b16 v[38:39], v9 offset:2816
    s_add_u32 m0, s23, 0
    s_nop 0
    buffer_load_dwordx4 v15, s[8:11], s19 offen lds
    v_mfma_f32_32x32x16_bf16 v[112:127], v[52:55], v[228:231], v[112:127]
    s_add_u32 m0, s23, 8192
    s_nop 0
    buffer_load_dwordx4 v16, s[8:11], s19 offen lds
    s_add_u32 m0, s23, 16384
    s_nop 0
    buffer_load_dwordx4 v17, s[8:11], s19 offen lds
    v_mfma_f32_32x32x16_bf16 v[128:143], v[56:59], v[228:231], v[128:143]
    buffer_load_dwordx4 v[224:227], v14, s[4:7], s18 offen offset:0 sc1
    buffer_load_dwordx4 v[228:231], v14, s[4:7], s18 offen offset:1024 sc1
    s_add_u32 s19, s19, 81920
    s_add_u32 s18, s18, 4096
    s_waitcnt lgkmcnt(0)
    v_mfma_f32_32x32x16_bf16 v[64:79], v[20:23], v[232:235], v[64:79]
    ds_read_b64_tr_b16 v[40:41], v9 offset:5120
    ds_read_b64_tr_b16 v[42:43], v9 offset:7680
    v_mfma_f32_32x32x16_bf16 v[80:95], v[24:27], v[232:235], v[80:95]
    ds_read_b64_tr_b16 v[44:45], v9 offset:5184
    ds_read_b64_tr_b16 v[46:47], v9 offset:7744
    v_mfma_f32_32x32x16_bf16 v[96:111], v[28:31], v[232:235], v[96:111]
    ds_read_b64_tr_b16 v[48:49], v9 offset:5248
    ds_read_b64_tr_b16 v[50:51], v9 offset:7808
    v_mfma_f32_32x32x16_bf16 v[112:127], v[32:35], v[232:235], v[112:127]
    ds_read_b64_tr_b16 v[52:53], v9 offset:5312
    ds_read_b64_tr_b16 v[54:55], v9 offset:7872
    v_mfma_f32_32x32x16_bf16 v[128:143], v[36:39], v[232:235], v[128:143]
    ds_read_b64_tr_b16 v[56:57], v9 offset:5376
    ds_read_b64_tr_b16 v[58:59], v9 offset:7936
    s_nop 0
    s_waitcnt vmcnt(10) lgkmcnt(0)
    s_barrier
    v_add_u32 v9, 32768, v7
    v_mfma_f32_32x32x16_bf16 v[64:79], v[40:43], v[236:239], v[64:79]
    ds_read_b64_tr_b16 v[20:21], v9 offset:0
    ds_read_b64_tr_b16 v[22:23], v9 offset:2560
    ds_read_b64_tr_b16 v[24:25], v9 offset:64
    ds_read_b64_tr_b16 v[26:27], v9 offset:2624
    v_mfma_f32_32x32x16_bf16 v[80:95], v[44:47], v[236:239], v[80:95]
    ds_read_b64_tr_b16 v[28:29], v9 offset:128
    ds_read_b64_tr_b16 v[30:31], v9 offset:2688
    ds_read_b64_tr_b16 v[32:33], v9 offset:192
    ds_read_b64_tr_b16 v[34:35], v9 offset:2752
    v_mfma_f32_32x32x16_bf16 v[96:111], v[48:51], v[236:239], v[96:111]
    ds_read_b64_tr_b16 v[36:37], v9 offset:256
    ds_read_b64_tr_b16 v[38:39], v9 offset:2816
    s_add_u32 m0, s23, 65536
    s_nop 0
    buffer_load_dwordx4 v15, s[8:11], s19 offen lds
    v_mfma_f32_32x32x16_bf16 v[112:127], v[52:55], v[236:239], v[112:127]
    s_add_u32 m0, s23, 73728
    s_nop 0
    buffer_load_dwordx4 v16, s[8:11], s19 offen lds
    s_add_u32 m0, s23, 81920
    s_nop 0
    buffer_load_dwordx4 v17, s[8:11], s19 offen lds
    v_mfma_f32_32x32x16_bf16 v[128:143], v[56:59], v[236:239], v[128:143]
    buffer_load_dwordx4 v[232:235], v14, s[4:7], s18 offen offset:0 sc1
    buffer_load_dwordx4 v[236:239], v14, s[4:7], s18 offen offset:1024 sc1
    s_add_u32 s19, s19, 81920
    s_add_u32 s18, s18, 4096
    s_waitcnt lgkmcnt(0)
    v_mfma_f32_32x32x16_bf16 v[64:79], v[20:23], v[208:211], v[64:79]
    ds_read_b64_tr_b16 v[40:41], v9 offset:5120
    ds_read_b64_tr_b16 v[42:43], v9 offset:7680
    v_mfma_f32_32x32x16_bf16 v[80:95], v[24:27], v[208:211], v[80:95]
    ds_read_b64_tr_b16 v[44:45], v9 offset:5184
    ds_read_b64_tr_b16 v[46:47], v9 offset:7744
    v_mfma_f32_32x32x16_bf16 v[96:111], v[28:31], v[208:211], v[96:111]
    ds_read_b64_tr_b16 v[48:49], v9 offset:5248
    ds_read_b64_tr_b16 v[50:51], v9 offset:7808
    v_mfma_f32_32x32x16_bf16 v[112:127], v[32:35], v[208:211], v[112:127]
    ds_read_b64_tr_b16 v[52:53], v9 offset:5312
    ds_read_b64_tr_b16 v[54:55], v9 offset:7872
    v_mfma_f32_32x32x16_bf16 v[128:143], v[36:39], v[208:211], v[128:143]
    ds_read_b64_tr_b16 v[56:57], v9 offset:5376
    ds_read_b64_tr_b16 v[58:59], v9 offset:7936
    s_nop 0
    s_waitcnt vmcnt(10) lgkmcnt(0)
    s_barrier
    v_add_u32 v9, 98304, v7
    v_mfma_f32_32x32x16_bf16 v[64:79], v[40:43], v[212:215], v[64:79]
    ds_read_b64_tr_b16 v[20:21], v9 offset:0
    ds_read_b64_tr_b16 v[22:23], v9 offset:2560
    ds_read_b64_tr_b16 v[24:25], v9 offset:64
    ds_read_b64_tr_b16 v[26:27], v9 offset:2624
    v_mfma_f32_32x32x16_bf16 v[80:95], v[44:47], v[212:215], v[80:95]
    ds_read_b64_tr_b16 v[28:29], v9 offset:128
    ds_read_b64_tr_b16 v[30:31], v9 offset:2688
    ds_read_b64_tr_b16 v[32:33], v9 offset:192
    ds_read_b64_tr_b16 v[34:35], v9 offset:2752
    v_mfma_f32_32x32x16_bf16 v[96:111], v[48:51], v[212:215], v[96:111]
    ds_read_b64_tr_b16 v[36:37], v9 offset:256
    ds_read_b64_tr_b16 v[38:39], v9 offset:2816
    s_add_u32 m0, s23, 32768
    s_nop 0
    buffer_load_dwordx4 v15, s[8:11], s19 offen lds
    v_mfma_f32_32x32x16_bf16 v[112:127], v[52:55], v[212:215], v[112:127]
    s_add_u32 m0, s23, 40960
    s_nop 0
    buffer_load_dwordx4 v16, s[8:11], s19 offen lds
    s_add_u32 m0, s23, 49152
    s_nop 0
    buffer_load_dwordx4 v17, s[8:11], s19 offen lds
    v_mfma_f32_32x32x16_bf16 v[128:143], v[56:59], v[212:215], v[128:143]
    buffer_load_dwordx4 v[208:211], v14, s[4:7], s18 offen offset:0 sc1
    buffer_load_dwordx4 v[212:215], v14, s[4:7], s18 offen offset:1024 sc1
    s_add_u32 s19, s19, 81920
    s_add_u32 s18, s18, 4096
    s_mov_b32 s16, 4
Lk_48:
    s_waitcnt lgkmcnt(0)
    v_mfma_f32_32x32x16_bf16 v[64:79], v[20:23], v[216:219], v[64:79]
    ds_read_b64_tr_b16 v[40:41], v9 offset:5120
    ds_read_b64_tr_b16 v[42:43], v9 offset:7680
    v_mfma_f32_32x32x16_bf16 v[80:95], v[24:27], v[216:219], v[80:95]
    ds_read_b64_tr_b16 v[44:45], v9 offset:5184
    ds_read_b64_tr_b16 v[46:47], v9 offset:7744
    v_mfma_f32_32x32x16_bf16 v[96:111], v[28:31], v[216:219], v[96:111]
    ds_read_b64_tr_b16 v[48:49], v9 offset:5248
    ds_read_b64_tr_b16 v[50:51], v9 offset:7808
    v_mfma_f32_32x32x16_bf16 v[112:127], v[32:35], v[216:219], v[112:127]
    ds_read_b64_tr_b16 v[52:53], v9 offset:5312
    ds_read_b64_tr_b16 v[54:55], v9 offset:7872
    v_mfma_f32_32x32x16_bf16 v[128:143], v[36:39], v[216:219], v[128:143]
    ds_read_b64_tr_b16 v[56:57], v9 offset:5376
    ds_read_b64_tr_b16 v[58:59], v9 offset:7936
    s_cmp_eq_u32 s16, 1
    s_cselect_b32 s6, 0, s6
    s_cselect_b32 s10, 0, s10
    s_waitcnt vmcnt(10) lgkmcnt(0)
    s_barrier
    v_add_u32 v9, 0, v7
    v_mfma_f32_32x32x16_bf16 v[64:79], v[40:43], v[220:223], v[64:79]
    ds_read_b64_tr_b16 v[20:21], v9 offset:0
    ds_read_b64_tr_b16 v[22:23], v9 offset:2560
    ds_read_b64_tr_b16 v[24:25], v9 offset:64
    ds_read_b64_tr_b16 v[26:27], v9 offset:2624
    v_mfma_f32_32x32x16_bf16 v[80:95], v[44:47], v[220:223], v[80:95]
    ds_read_b64_tr_b16 v[28:29], v9 offset:128
    ds_read_b64_tr_b16 v[30:31], v9 offset:2688
    ds_read_b64_tr_b16 v[32:33], v9 offset:192
    ds_read_b64_tr_b16 v[34:35], v9 offset:2752
    v_mfma_f32_32x32x16_bf16 v[96:111], v[48:51], v[220:223], v[96:111]
    ds_read_b64_tr_b16 v[36:37], v9 offset:256
    ds_read_b64_tr_b16 v[38:39], v9 offset:2816
    s_add_u32 m0, s23, 98304
    s_nop 0
    buffer_load_dwordx4 v15, s[8:11], s19 offen lds
    v_mfma_f32_32x32x16_bf16 v[112:127], v[52:55], v[220:223], v[112:127]
    s_add_u32 m0, s23, 106496
    s_nop 0
    buffer_load_dwordx4 v16, s[8:11], s19 offen lds
    s_add_u32 m0, s23, 114688
    s_nop 0
    buffer_load_dwordx4 v17, s[8:11], s19 offen lds
    v_mfma_f32_32x32x16_bf16 v[128:143], v[56:59], v[220:223], v[128:143]
    buffer_load_dwordx4 v[216:219], v14, s[4:7], s18 offen offset:0 sc1
    buffer_load_dwordx4 v[220:223], v14, s[4:7], s18 offen offset:1024 sc1
    s_add_u32 s19, s19, 81920
    s_add_u32 s18, s18, 4096
    s_waitcnt lgkmcnt(0)
    v_mfma_f32_32x32x16_bf16 v[64:79], v[20:23], v[224:227], v[64:79]
    ds_read_b64_tr_b16 v[40:41], v9 offset:5120
    ds_read_b64_tr_b16 v[42:43], v9 offset:7680
    v_mfma_f32_32x32x16_bf16 v[80:95], v[24:27], v[224:227], v[80:95]
    ds_read_b64_tr_b16 v[44:45], v9 offset:5184
    ds_read_b64_tr_b16 v[46:47], v9 offset:7744
    v_mfma_f32_32x32x16_bf16 v[96:111], v[28:31], v[224:227], v[96:111]
    ds_read_b64_tr_b16 v[48:49], v9 offset:5248
    ds_read_b64_tr_b16 v[50:51], v9 offset:7808
    v_mfma_f32_32x32x16_bf16 v[112:127], v[32:35], v[224:227], v[112:127]
    ds_read_b64_tr_b16 v[52:53], v9 offset:5312
    ds_read_b64_tr_b16 v[54:55], v9 offset:7872
    v_mfma_f32_32x32x16_bf16 v[128:143], v[36:39], v[224:227], v[128:143]
    ds_read_b64_tr_b16 v[56:57], v9 offset:5376
    ds_read_b64_tr_b16 v[58:59], v9 offset:7936
    s_nop 0
    s_waitcnt vmcnt(10) lgkmcnt(0)
    s_barrier
    v_add_u32 v9, 65536, v7
    v_mfma_f32_32x32x16_bf16 v[64:79], v[40:43], v[228:231], v[64:79]
    ds_read_b64_tr_b16 v[20:21], v9 offset:0
    ds_read_b64_tr_b16 v[22:23], v9 offset:2560
    ds_read_b64_tr_b16 v[24:25], v9 offset:64
    ds_read_b64_tr_b16 v[26:27], v9 offset:2624
    v_mfma_f32_32x32x16_bf16 v[80:95], v[44:47], v[228:231], v[80:95]
    ds_read_b64_tr_b16 v[28:29], v9 offset:128
    ds_read_b64_tr_b16 v[30:31], v9 offset:2688
    ds_read_b64_tr_b16 v[32:33], v9 offset:192
    ds_read_b64_tr_b16 v[34:35], v9 offset:2752
    v_mfma_f32_32x32x16_bf16 v[96:111], v[48:51], v[228:231], v[96:111]
    ds_read_b64_tr_b16 v[36:37], v9 offset:256
    ds_read_b64_tr_b16 v[38:39], v9 offset:2816
    s_add_u32 m0, s23, 0
    s_nop 0
    buffer_load_dwordx4 v15, s[8:11], s19 offen lds
    v_mfma_f32_32x32x16_bf16 v[112:127], v[52:55], v[228:231], v[112:127]
    s_add_u32 m0, s23, 8192
    s_nop 0
    buffer_load_dwordx4 v16, s[8:11], s19 offen lds
    s_add_u32 m0, s23, 16384
    s_nop 0
    buffer_load_dwordx4 v17, s[8:11], s19 offen lds
    v_mfma_f32_32x32x16_bf16 v[128:143], v[56:59], v[228:231], v[128:143]
    buffer_load_dwordx4 v[224:227], v14, s[4:7], s18 offen offset:0 sc1
    buffer_load_dwordx4 v[228:231], v14, s[4:7], s18 offen offset:1024 sc1
    s_add_u32 s19, s19, 81920
    s_add_u32 s18, s18, 4096
    s_waitcnt lgkmcnt(0)
    v_mfma_f32_32x32x16_bf16 v[64:79], v[20:23], v[232:235], v[64:79]
    ds_read_b64_tr_b16 v[40:41], v9 offset:5120
    ds_read_b64_tr_b16 v[42:43], v9 offset:7680
    v_mfma_f32_32x32x16_bf16 v[80:95], v[24:27], v[232:235], v[80:95]
    ds_read_b64_tr_b16 v[44:45], v9 offset:5184
    ds_read_b64_tr_b16 v[46:47], v9 offset:7744
    v_mfma_f32_32x32x16_bf16 v[96:111], v[28:31], v[232:235], v[96:111]
    ds_read_b64_tr_b16 v[48:49], v9 offset:5248
    ds_read_b64_tr_b16 v[50:51], v9 offset:7808
    v_mfma_f32_32x32x16_bf16 v[112:127], v[32:35], v[232:235], v[112:127]
    ds_read_b64_tr_b16 v[52:53], v9 offset:5312
    ds_read_b64_tr_b16 v[54:55], v9 offset:7872
    v_mfma_f32_32x32x16_bf16 v[128:143], v[36:39], v[232:235], v[128:143]
    ds_read_b64_tr_b16 v[56:57], v9 offset:5376
    ds_read_b64_tr_b16 v[58:59], v9 offset:7936
    s_nop 0
    s_waitcnt vmcnt(10) lgkmcnt(0)
    s_barrier
    v_add_u32 v9, 32768, v7
    v_mfma_f32_32x32x16_bf16 v[64:79], v[40:43], v[236:239], v[64:79]
    ds_read_b64_tr_b16 v[20:21], v9 offset:0
    ds_read_b64_tr_b16 v[22:23], v9 offset:2560
    ds_read_b64_tr_b16 v[24:25], v9 offset:64
    ds_read_b64_tr_b16 v[26:27], v9 offset:2624
    v_mfma_f32_32x32x16_bf16 v[80:95], v[44:47], v[236:239], v[80:95]
    ds_read_b64_tr_b16 v[28:29], v9 offset:128
    ds_read_b64_tr_b16 v[30:31], v9 offset:2688
    ds_read_b64_tr_b16 v[32:33], v9 offset:192
    ds_read_b64_tr_b16 v[34:35], v9 offset:2752
    v_mfma_f32_32x32x16_bf16 v[96:111], v[48:51], v[236:239], v[96:111]
    ds_read_b64_tr_b16 v[36:37], v9 offset:256
    ds_read_b64_tr_b16 v[38:39], v9 offset:2816
    s_add_u32 m0, s23, 65536
    s_nop 0
    buffer_load_dwordx4 v15, s[8:11], s19 offen lds
    v_mfma_f32_32x32x16_bf16 v[112:127], v[52:55], v[236:239], v[112:127]
    s_add_u32 m0, s23, 73728
    s_nop 0
    buffer_load_dwordx4 v16, s[8:11], s19 offen lds
    s_add_u32 m0, s23, 81920
    s_nop 0
    buffer_load_dwordx4 v17, s[8:11], s19 offen lds
    v_mfma_f32_32x32x16_bf16 v[128:143], v[56:59], v[236:239], v[128:143]
    buffer_load_dwordx4 v[232:235], v14, s[4:7], s18 offen offset:0 sc1
    buffer_load_dwordx4 v[236:239], v14, s[4:7], s18 offen offset:1024 sc1
    s_add_u32 s19, s19, 81920
    s_add_u32 s18, s18, 4096
    s_waitcnt lgkmcnt(0)
    v_mfma_f32_32x32x16_bf16 v[64:79], v[20:23], v[208:211], v[64:79]
    ds_read_b64_tr_b16 v[40:41], v9 offset:5120
    ds_read_b64_tr_b16 v[42:43], v9 offset:7680
    v_mfma_f32_32x32x16_bf16 v[80:95], v[24:27], v[208:211], v[80:95]
    ds_read_b64_tr_b16 v[44:45], v9 offset:5184
    ds_read_b64_tr_b16 v[46:47], v9 offset:7744
    v_mfma_f32_32x32x16_bf16 v[96:111], v[28:31], v[208:211], v[96:111]
    ds_read_b64_tr_b16 v[48:49], v9 offset:5248
    ds_read_b64_tr_b16 v[50:51], v9 offset:7808
    v_mfma_f32_32x32x16_bf16 v[112:127], v[32:35], v[208:211], v[112:127]
    ds_read_b64_tr_b16 v[52:53], v9 offset:5312
    ds_read_b64_tr_b16 v[54:55], v9 offset:7872
    v_mfma_f32_32x32x16_bf16 v[128:143], v[36:39], v[208:211], v[128:143]
    ds_read_b64_tr_b16 v[56:57], v9 offset:5376
    ds_read_b64_tr_b16 v[58:59], v9 offset:7936
    s_nop 0
    s_waitcnt vmcnt(10) lgkmcnt(0)
    s_barrier
    v_add_u32 v9, 98304, v7
    v_mfma_f32_32x32x16_bf16 v[64:79], v[40:43], v[212:215], v[64:79]
    ds_read_b64_tr_b16 v[20:21], v9 offset:0
    ds_read_b64_tr_b16 v[22:23], v9 offset:2560
    ds_read_b64_tr_b16 v[24:25], v9 offset:64
    ds_read_b64_tr_b16 v[26:27], v9 offset:2624
    v_mfma_f32_32x32x16_bf16 v[80:95], v[44:47], v[212:215], v[80:95]
    ds_read_b64_tr_b16 v[28:29], v9 offset:128
    ds_read_b64_tr_b16 v[30:31], v9 offset:2688
    ds_read_b64_tr_b16 v[32:33], v9 offset:192
    ds_read_b64_tr_b16 v[34:35], v9 offset:2752
    v_mfma_f32_32x32x16_bf16 v[96:111], v[48:51], v[212:215], v[96:111]
    ds_read_b64_tr_b16 v[36:37], v9 offset:256
    ds_read_b64_tr_b16 v[38:39], v9 offset:2816
    s_add_u32 m0, s23, 32768
    s_nop 0
    buffer_load_dwordx4 v15, s[8:11], s19 offen lds
    v_mfma_f32_32x32x16_bf16 v[112:127], v[52:55], v[212:215], v[112:127]
    s_add_u32 m0, s23, 40960
    s_nop 0
    buffer_load_dwordx4 v16, s[8:11], s19 offen lds
    s_add_u32 m0, s23, 49152
    s_nop 0
    buffer_load_dwordx4 v17, s[8:11], s19 offen lds
    v_mfma_f32_32x32x16_bf16 v[128:143], v[56:59], v[212:215], v[128:143]
    buffer_load_dwordx4 v[208:211], v14, s[4:7], s18 offen offset:0 sc1
    buffer_load_dwordx4 v[212:215], v14, s[4:7], s18 offen offset:1024 sc1
    s_add_u32 s19, s19, 81920
    s_add_u32 s18, s18, 4096
    s_sub_u32 s16, s16, 1
    s_cmp_lg_u32 s16, 0
    s_cbranch_scc1 Lk_48
    s_mul_i32 s30, s21, 10240
    s_xor_b32 s31, s21, 4
    s_mul_i32 s31, s31, 10240
    v_add_u32 v7, s30, v10
    v_add_u32 v9, s31, v10
    s_waitcnt vmcnt(0) lgkmcnt(0)
    s_barrier
    s_nop 7
    s_cmp_eq_u32 s35, 1
    s_cbranch_scc1 Lg_49
    ds_write_b128 v7, v[104:107] offset:0
    ds_write_b128 v7, v[108:111] offset:1024
    ds_write_b128 v7, v[112:115] offset:2048
    ds_write_b128 v7, v[116:119] offset:3072
    ds_write_b128 v7, v[120:123] offset:4096
    ds_write_b128 v7, v[124:127] offset:5120
    ds_write_b128 v7, v[128:131] offset:6144
    ds_write_b128 v7, v[132:135] offset:7168
    ds_write_b128 v7, v[136:139] offset:8192
    ds_write_b128 v7, v[140:143] offset:9216
    s_branch Lg_50
Lg_49:
    ds_write_b128 v7, v[64:67] offset:0
    ds_write_b128 v7, v[68:71] offset:1024
    ds_write_b128 v7, v[72:75] offset:2048
    ds_write_b128 v7, v[76:79] offset:3072
    ds_write_b128 v7, v[80:83] offset:4096
    ds_write_b128 v7, v[84:87] offset:5120
    ds_write_b128 v7, v[88:91] offset:6144
    ds_write_b128 v7, v[92:95] offset:7168
    ds_write_b128 v7, v[96:99] offset:8192
    ds_write_b128 v7, v[100:103] offset:9216
    s_nop 1
    v_mov_b32 v64, v104
    v_mov_b32 v65, v105
    v_mov_b32 v66, v106
    v_mov_b32 v67, v107
    v_mov_b32 v68, v108
    v_mov_b32 v69, v109
    v_mov_b32 v70, v110
    v_mov_b32 v71, v111
    v_mov_b32 v72, v112
    v_mov_b32 v73, v113
    v_mov_b32 v74, v114
    v_mov_b32 v75, v115
    v_mov_b32 v76, v116
    v_mov_b32 v77, v117
    v_mov_b32 v78, v118
    v_mov_b32 v79, v119
    v_mov_b32 v80, v120
    v_mov_b32 v81, v121
    v_mov_b32 v82, v122
    v_mov_b32 v83, v123
    v_mov_b32 v84, v124
    v_mov_b32 v85, v125
    v_mov_b32 v86, v126
    v_mov_b32 v87, v127
    v_mov_b32 v88, v128
    v_mov_b32 v89, v129
    v_mov_b32 v90, v130
    v_mov_b32 v91, v131
    v_mov_b32 v92, v132
    v_mov_b32 v93, v133
    v_mov_b32 v94, v134
    v_mov_b32 v95, v135
    v_mov_b32 v96, v136
    v_mov_b32 v97, v137
    v_mov_b32 v98, v138
    v_mov_b32 v99, v139
    v_mov_b32 v100, v140
    v_mov_b32 v101, v141
    v_mov_b32 v102, v142
    v_mov_b32 v103, v143
Lg_50:
    s_waitcnt lgkmcnt(0)
    s_barrier
    s_nop 0
    ds_read_b128 v[104:107], v9 offset:0
    ds_read_b128 v[108:111], v9 offset:1024
    ds_read_b128 v[112:115], v9 offset:2048
    ds_read_b128 v[116:119], v9 offset:3072
    ds_read_b128 v[120:123], v9 offset:4096
    ds_read_b128 v[124:127], v9 offset:5120
    ds_read_b128 v[128:131], v9 offset:6144
    ds_read_b128 v[132:135], v9 offset:7168
    ds_read_b128 v[136:139], v9 offset:8192
    ds_read_b128 v[140:143], v9 offset:9216
    s_mov_b32 s44, s48
    s_and_b32 s45, s49, 0xffff
    s_mov_b32 s46, 2621440
    s_mov_b32 s47, 0x00020000
    s_mov_b32 s48, s52
    s_and_b32 s49, s53, 0xffff
    s_mov_b32 s50, 2621440
    s_mov_b32 s51, 0x00020000
    s_lshl_b32 s33, s37, 2
    s_add_u32 s33, s33, s36
    s_mul_i32 s30, s33, 163840
    s_mul_i32 s31, s34, 2560
    s_add_u32 s30, s30, s31
    s_add_u32 s30, s30, 83886080
    s_lshl_b32 s33, s33, 2
    s_lshl_b32 s31, s37, 7
    s_lshl_b32 s32, s34, 5
    s_add_u32 s31, s31, s32
    v_and_b32 v176, 31, v1
    v_add_u32 v176, s31, v176
    s_movk_i32 s31, 1280
    v_mul_lo_u32 v176, v176, s31
    v_lshrrev_b32 v177, 5, v1
    v_lshl_add_u32 v176, v177, 3, v176
    s_mul_i32 s31, s36, 320
    s_mul_i32 s32, s38, 80
    s_add_u32 s39, s31, s32
    v_lshlrev_b32 v178, 3, v1
    s_waitcnt lgkmcnt(5)
    v_add_f32 v64, v64, v104
    v_add_f32 v65, v65, v105
    v_add_f32 v66, v66, v106
    v_add_f32 v67, v67, v107
    v_add_f32 v68, v68, v108
    v_add_f32 v69, v69, v109
    v_add_f32 v70, v70, v110
    v_add_f32 v71, v71, v111
    v_add_f32 v72, v72, v112
    v_add_f32 v73, v73, v113
    v_add_f32 v74, v74, v114
    v_add_f32 v75, v75, v115
    v_add_f32 v76, v76, v116
    v_add_f32 v77, v77, v117
    v_add_f32 v78, v78, v118
    v_add_f32 v79, v79, v119
    v_add_f32 v80, v80, v120
    v_add_f32 v81, v81, v121
    v_add_f32 v82, v82, v122
    v_add_f32 v83, v83, v123
    s_lshl_b32 s31, s35, 1
    s_add_u32 s31, s31, 0
    s_cmp_eq_u32 s31, s38
    s_cbranch_scc1 Lk_51
    s_lshl_b32 s31, s31, 2
    s_add_u32 s31, s31, s38
    s_mul_i32 s31, s31, 10240
    s_add_u32 s31, s31, s30
    v_cvt_pk_bf16_f32 v104, v64, v65
    v_cvt_pk_bf16_f32 v105, v66, v67
    v_cvt_pk_bf16_f32 v106, v68, v69
    v_cvt_pk_bf16_f32 v107, v70, v71
    v_cvt_pk_bf16_f32 v108, v72, v73
    v_cvt_pk_bf16_f32 v109, v74, v75
    v_cvt_pk_bf16_f32 v110, v76, v77
    v_cvt_pk_bf16_f32 v111, v78, v79
    v_cvt_pk_bf16_f32 v112, v80, v81
    v_cvt_pk_bf16_f32 v113, v82, v83
    buffer_store_dwordx4 v[104:107], v10, s[12:15], s31 offen sc1
    buffer_store_dwordx4 v[108:111], v10, s[12:15], s31 offen offset:1024 sc1
    buffer_store_dwordx2 v[112:113], v178, s[12:15], s31 offen offset:2048 sc1
    s_branch Lk_52
Lk_51:
    v_mov_b32 v144, v64
    v_mov_b32 v145, v65
    v_mov_b32 v146, v66
    v_mov_b32 v147, v67
    v_mov_b32 v148, v68
    v_mov_b32 v149, v69
    v_mov_b32 v150, v70
    v_mov_b32 v151, v71
    v_mov_b32 v152, v72
    v_mov_b32 v153, v73
    v_mov_b32 v154, v74
    v_mov_b32 v155, v75
    v_mov_b32 v156, v76
    v_mov_b32 v157, v77
    v_mov_b32 v158, v78
    v_mov_b32 v159, v79
    v_mov_b32 v160, v80
    v_mov_b32 v161, v81
    v_mov_b32 v162, v82
    v_mov_b32 v163, v83
    buffer_load_dwordx2 v[20:21], v176, s[44:47], s39 offen offset:0
    buffer_load_dwordx2 v[22:23], v176, s[44:47], s39 offen offset:16
    buffer_load_dwordx2 v[24:25], v176, s[44:47], s39 offen offset:32
    buffer_load_dwordx2 v[26:27], v176, s[44:47], s39 offen offset:48
    buffer_load_dwordx2 v[28:29], v176, s[44:47], s39 offen offset:64
Lk_52:
    s_waitcnt lgkmcnt(0)
    v_add_f32 v84, v84, v124
    v_add_f32 v85, v85, v125
    v_add_f32 v86, v86, v126
    v_add_f32 v87, v87, v127
    v_add_f32 v88, v88, v128
    v_add_f32 v89, v89, v129
    v_add_f32 v90, v90, v130
    v_add_f32 v91, v91, v131
    v_add_f32 v92, v92, v132
    v_add_f32 v93, v93, v133
    v_add_f32 v94, v94, v134
    v_add_f32 v95, v95, v135
    v_add_f32 v96, v96, v136
    v_add_f32 v97, v97, v137
    v_add_f32 v98, v98, v138
    v_add_f32 v99, v99, v139
    v_add_f32 v100, v100, v140
    v_add_f32 v101, v101, v141
    v_add_f32 v102, v102, v142
    v_add_f32 v103, v103, v143
    s_lshl_b32 s31, s35, 1
    s_add_u32 s31, s31, 1
    s_cmp_eq_u32 s31, s38
    s_cbranch_scc1 Lk_53
    s_lshl_b32 s31, s31, 2
    s_add_u32 s31, s31, s38
    s_mul_i32 s31, s31, 10240
    s_add_u32 s31, s31, s30
    v_cvt_pk_bf16_f32 v124, v84, v85
    v_cvt_pk_bf16_f32 v125, v86, v87
    v_cvt_pk_bf16_f32 v126, v88, v89
    v_cvt_pk_bf16_f32 v127, v90, v91
    v_cvt_pk_bf16_f32 v128, v92, v93
    v_cvt_pk_bf16_f32 v129, v94, v95
    v_cvt_pk_bf16_f32 v130, v96, v97
    v_cvt_pk_bf16_f32 v131, v98, v99
    v_cvt_pk_bf16_f32 v132, v100, v101
    v_cvt_pk_bf16_f32 v133, v102, v103
    buffer_store_dwordx4 v[124:127], v10, s[12:15], s31 offen sc1
    buffer_store_dwordx4 v[128:131], v10, s[12:15], s31 offen offset:1024 sc1
    buffer_store_dwordx2 v[132:133], v178, s[12:15], s31 offen offset:2048 sc1
    s_branch Lk_54
Lk_53:
    v_mov_b32 v144, v84
    v_mov_b32 v145, v85
    v_mov_b32 v146, v86
    v_mov_b32 v147, v87
    v_mov_b32 v148, v88
    v_mov_b32 v149, v89
    v_mov_b32 v150, v90
    v_mov_b32 v151, v91
    v_mov_b32 v152, v92
    v_mov_b32 v153, v93
    v_mov_b32 v154, v94
    v_mov_b32 v155, v95
    v_mov_b32 v156, v96
    v_mov_b32 v157, v97
    v_mov_b32 v158, v98
    v_mov_b32 v159, v99
    v_mov_b32 v160, v100
    v_mov_b32 v161, v101
    v_mov_b32 v162, v102
    v_mov_b32 v163, v103
    buffer_load_dwordx2 v[20:21], v176, s[44:47], s39 offen offset:0
    buffer_load_dwordx2 v[22:23], v176, s[44:47], s39 offen offset:16
    buffer_load_dwordx2 v[24:25], v176, s[44:47], s39 offen offset:32
    buffer_load_dwordx2 v[26:27], v176, s[44:47], s39 offen offset:48
    buffer_load_dwordx2 v[28:29], v176, s[44:47], s39 offen offset:64
Lk_54:
    s_lshl_b32 s33, s33, 2
    s_add_u32 s33, s33, s34
    s_lshl_b32 s33, s33, 8
    s_add_u32 s33, s33, 117440512
    s_lshl_b32 s31, s35, 11
    s_lshl_b32 s32, s38, 2
    s_add_u32 s31, s31, s32
    s_add_u32 s31, s31, s33
    v_lshlrev_b32 v11, 10, v1
    v_mov_b32 v179, 1
    s_mov_b64 exec, 3
    s_waitcnt vmcnt(0)
    buffer_store_dword v179, v11, s[12:15], s31 offen sc1
    s_mov_b64 exec, -1
    s_lshr_b32 s31, s38, 1
    s_cmp_eq_u32 s31, s35
    s_cbranch_scc0 attn_kernel_done
    s_lshl_b32 s31, s38, 10
    s_add_u32 s33, s33, s31
    v_and_b32 v11, 3, v1
    v_lshlrev_b32 v11, 2, v11
Lpoll_55:
    buffer_load_dword v179, v11, s[12:15], s33 offen sc1
    s_waitcnt vmcnt(0)
    v_cmp_eq_u32 vcc, 0, v179
    s_cbranch_vccz Lrdy_56
    s_sleep 2
    s_branch Lpoll_55
Lrdy_56:
    s_add_u32 s31, s38, 1
    s_and_b32 s31, s31, 3
    s_lshl_b32 s32, s38, 2
    s_add_u32 s31, s31, s32
    s_mul_i32 s31, s31, 10240
    s_add_u32 s31, s31, s30
    buffer_load_dwordx4 v[64:67], v10, s[12:15], s31 offen sc1
    buffer_load_dwordx4 v[68:71], v10, s[12:15], s31 offen offset:1024 sc1
    buffer_load_dwordx2 v[72:73], v178, s[12:15], s31 offen offset:2048 sc1
    s_add_u32 s31, s38, 2
    s_and_b32 s31, s31, 3
    s_lshl_b32 s32, s38, 2
    s_add_u32 s31, s31, s32
    s_mul_i32 s31, s31, 10240
    s_add_u32 s31, s31, s30
    buffer_load_dwordx4 v[84:87], v10, s[12:15], s31 offen sc1
    buffer_load_dwordx4 v[88:91], v10, s[12:15], s31 offen offset:1024 sc1
    buffer_load_dwordx2 v[92:93], v178, s[12:15], s31 offen offset:2048 sc1
    s_add_u32 s31, s38, 3
    s_and_b32 s31, s31, 3
    s_lshl_b32 s32, s38, 2
    s_add_u32 s31, s31, s32
    s_mul_i32 s31, s31, 10240
    s_add_u32 s31, s31, s30
    buffer_load_dwordx4 v[104:107], v10, s[12:15], s31 offen sc1
    buffer_load_dwordx4 v[108:111], v10, s[12:15], s31 offen offset:1024 sc1
    buffer_load_dwordx2 v[112:113], v178, s[12:15], s31 offen offset:2048 sc1
    s_waitcnt vmcnt(6)
    v_lshlrev_b32 v180, 16, v64
    v_and_b32 v181, 0xffff0000, v64
    v_add_f32 v144, v144, v180
    v_add_f32 v145, v145, v181
    v_lshlrev_b32 v180, 16, v65
    v_and_b32 v181, 0xffff0000, v65
    v_add_f32 v146, v146, v180
    v_add_f32 v147, v147, v181
    v_lshlrev_b32 v180, 16, v66
    v_and_b32 v181, 0xffff0000, v66
    v_add_f32 v148, v148, v180
    v_add_f32 v149, v149, v181
    v_lshlrev_b32 v180, 16, v67
    v_and_b32 v181, 0xffff0000, v67
    v_add_f32 v150, v150, v180
    v_add_f32 v151, v151, v181
    v_lshlrev_b32 v180, 16, v68
    v_and_b32 v181, 0xffff0000, v68
    v_add_f32 v152, v152, v180
    v_add_f32 v153, v153, v181
    v_lshlrev_b32 v180, 16, v69
    v_and_b32 v181, 0xffff0000, v69
    v_add_f32 v154, v154, v180
    v_add_f32 v155, v155, v181
    v_lshlrev_b32 v180, 16, v70
    v_and_b32 v181, 0xffff0000, v70
    v_add_f32 v156, v156, v180
    v_add_f32 v157, v157, v181
    v_lshlrev_b32 v180, 16, v71
    v_and_b32 v181, 0xffff0000, v71
    v_add_f32 v158, v158, v180
    v_add_f32 v159, v159, v181
    v_lshlrev_b32 v180, 16, v72
    v_and_b32 v181, 0xffff0000, v72
    v_add_f32 v160, v160, v180
    v_add_f32 v161, v161, v181
    v_lshlrev_b32 v180, 16, v73
    v_and_b32 v181, 0xffff0000, v73
    v_add_f32 v162, v162, v180
    v_add_f32 v163, v163, v181
    s_waitcnt vmcnt(3)
    v_lshlrev_b32 v180, 16, v84
    v_and_b32 v181, 0xffff0000, v84
    v_add_f32 v144, v144, v180
    v_add_f32 v145, v145, v181
    v_lshlrev_b32 v180, 16, v85
    v_and_b32 v181, 0xffff0000, v85
    v_add_f32 v146, v146, v180
    v_add_f32 v147, v147, v181
    v_lshlrev_b32 v180, 16, v86
    v_and_b32 v181, 0xffff0000, v86
    v_add_f32 v148, v148, v180
    v_add_f32 v149, v149, v181
    v_lshlrev_b32 v180, 16, v87
    v_and_b32 v181, 0xffff0000, v87
    v_add_f32 v150, v150, v180
    v_add_f32 v151, v151, v181
    v_lshlrev_b32 v180, 16, v88
    v_and_b32 v181, 0xffff0000, v88
    v_add_f32 v152, v152, v180
    v_add_f32 v153, v153, v181
    v_lshlrev_b32 v180, 16, v89
    v_and_b32 v181, 0xffff0000, v89
    v_add_f32 v154, v154, v180
    v_add_f32 v155, v155, v181
    v_lshlrev_b32 v180, 16, v90
    v_and_b32 v181, 0xffff0000, v90
    v_add_f32 v156, v156, v180
    v_add_f32 v157, v157, v181
    v_lshlrev_b32 v180, 16, v91
    v_and_b32 v181, 0xffff0000, v91
    v_add_f32 v158, v158, v180
    v_add_f32 v159, v159, v181
    v_lshlrev_b32 v180, 16, v92
    v_and_b32 v181, 0xffff0000, v92
    v_add_f32 v160, v160, v180
    v_add_f32 v161, v161, v181
    v_lshlrev_b32 v180, 16, v93
    v_and_b32 v181, 0xffff0000, v93
    v_add_f32 v162, v162, v180
    v_add_f32 v163, v163, v181
    s_waitcnt vmcnt(0)
    v_lshlrev_b32 v180, 16, v104
    v_and_b32 v181, 0xffff0000, v104
    v_add_f32 v144, v144, v180
    v_add_f32 v145, v145, v181
    v_lshlrev_b32 v180, 16, v105
    v_and_b32 v181, 0xffff0000, v105
    v_add_f32 v146, v146, v180
    v_add_f32 v147, v147, v181
    v_lshlrev_b32 v180, 16, v106
    v_and_b32 v181, 0xffff0000, v106
    v_add_f32 v148, v148, v180
    v_add_f32 v149, v149, v181
    v_lshlrev_b32 v180, 16, v107
    v_and_b32 v181, 0xffff0000, v107
    v_add_f32 v150, v150, v180
    v_add_f32 v151, v151, v181
    v_lshlrev_b32 v180, 16, v108
    v_and_b32 v181, 0xffff0000, v108
    v_add_f32 v152, v152, v180
    v_add_f32 v153, v153, v181
    v_lshlrev_b32 v180, 16, v109
    v_and_b32 v181, 0xffff0000, v109
    v_add_f32 v154, v154, v180
    v_add_f32 v155, v155, v181
    v_lshlrev_b32 v180, 16, v110
    v_and_b32 v181, 0xffff0000, v110
    v_add_f32 v156, v156, v180
    v_add_f32 v157, v157, v181
    v_lshlrev_b32 v180, 16, v111
    v_and_b32 v181, 0xffff0000, v111
    v_add_f32 v158, v158, v180
    v_add_f32 v159, v159, v181
    v_lshlrev_b32 v180, 16, v112
    v_and_b32 v181, 0xffff0000, v112
    v_add_f32 v160, v160, v180
    v_add_f32 v161, v161, v181
    v_lshlrev_b32 v180, 16, v113
    v_and_b32 v181, 0xffff0000, v113
    v_add_f32 v162, v162, v180
    v_add_f32 v163, v163, v181
    v_lshlrev_b32 v180, 16, v20
    v_and_b32 v181, 0xffff0000, v20
    v_add_f32 v144, v144, v180
    v_add_f32 v145, v145, v181
    v_cvt_pk_bf16_f32 v20, v144, v145
    v_lshlrev_b32 v180, 16, v21
    v_and_b32 v181, 0xffff0000, v21
    v_add_f32 v146, v146, v180
    v_add_f32 v147, v147, v181
    v_cvt_pk_bf16_f32 v21, v146, v147
    buffer_store_dwordx2 v[20:21], v176, s[48:51], s39 offen offset:0
    v_lshlrev_b32 v180, 16, v22
    v_and_b32 v181, 0xffff0000, v22
    v_add_f32 v148, v148, v180
    v_add_f32 v149, v149, v181
    v_cvt_pk_bf16_f32 v22, v148, v149
    v_lshlrev_b32 v180, 16, v23
    v_and_b32 v181, 0xffff0000, v23
    v_add_f32 v150, v150, v180
    v_add_f32 v151, v151, v181
    v_cvt_pk_bf16_f32 v23, v150, v151
    buffer_store_dwordx2 v[22:23], v176, s[48:51], s39 offen offset:16
    v_lshlrev_b32 v180, 16, v24
    v_and_b32 v181, 0xffff0000, v24
    v_add_f32 v152, v152, v180
    v_add_f32 v153, v153, v181
    v_cvt_pk_bf16_f32 v24, v152, v153
    v_lshlrev_b32 v180, 16, v25
    v_and_b32 v181, 0xffff0000, v25
    v_add_f32 v154, v154, v180
    v_add_f32 v155, v155, v181
    v_cvt_pk_bf16_f32 v25, v154, v155
    buffer_store_dwordx2 v[24:25], v176, s[48:51], s39 offen offset:32
    v_lshlrev_b32 v180, 16, v26
    v_and_b32 v181, 0xffff0000, v26
    v_add_f32 v156, v156, v180
    v_add_f32 v157, v157, v181
    v_cvt_pk_bf16_f32 v26, v156, v157
    v_lshlrev_b32 v180, 16, v27
    v_and_b32 v181, 0xffff0000, v27
    v_add_f32 v158, v158, v180
    v_add_f32 v159, v159, v181
    v_cvt_pk_bf16_f32 v27, v158, v159
    buffer_store_dwordx2 v[26:27], v176, s[48:51], s39 offen offset:48
    v_lshlrev_b32 v180, 16, v28
    v_and_b32 v181, 0xffff0000, v28
    v_add_f32 v160, v160, v180
    v_add_f32 v161, v161, v181
    v_cvt_pk_bf16_f32 v28, v160, v161
    v_lshlrev_b32 v180, 16, v29
    v_and_b32 v181, 0xffff0000, v29
    v_add_f32 v162, v162, v180
    v_add_f32 v163, v163, v181
    v_cvt_pk_bf16_f32 v29, v162, v163
    buffer_store_dwordx2 v[28:29], v176, s[48:51], s39 offen offset:64
attn_kernel_done:
    s_endpgm
Lcode_end:
.section .rodata,"a"
.p2align 6
.amdhsa_kernel proj_kernel
  .amdhsa_next_free_vgpr 256
  .amdhsa_next_free_sgpr 72
  .amdhsa_accum_offset 256
  .amdhsa_group_segment_fixed_size 0
  .amdhsa_kernarg_size 104
  .amdhsa_user_sgpr_count 2
  .amdhsa_user_sgpr_kernarg_segment_ptr 1
  .amdhsa_system_sgpr_workgroup_id_x 1
.end_amdhsa_kernel
```
